```python
import torch

def _softmax(x, axis=-1):
    return torch.softmax(x, dim=axis)
def _gelu(x):
    return torch.nn.functional.gelu(x, approximate="tanh")
def _silu(x):
    return torch.nn.functional.silu(x)
def _sigmoid(x):
    return torch.sigmoid(x)
def _layernorm(x, axis=-1, eps=1e-5):
    m = x.mean(dim=axis, keepdim=True)
    v = x.var(dim=axis, keepdim=True, unbiased=False)
    return (x - m) / torch.sqrt(v + eps)
def _scatter_add(tgt, idx, src, axis=0):
    return tgt.clone().index_add_(axis, idx, src)
def _segment_sum(src, seg, n):
    out = torch.zeros((n,) + src.shape[1:], dtype=src.dtype)
    return out.index_add_(0, seg, src)
def _pad(x, pw):
    flat = tuple(v for pair in reversed(pw) for v in pair)
    return torch.nn.functional.pad(x, flat)

kernel_name = 'standalone__mpnn_edge_mlp__graph'

def setup_inputs():

    _w = (lambda a: (lambda t: t.to(torch.bfloat16) if t.is_floating_point() else t)(torch.as_tensor(a)))
    N, deg, D, De = 10000, 16, 128, max(16, 1)
    E = N * deg
    return {
        "x": _w((lambda *s: torch.randn(*s, dtype=torch.bfloat16) * 0.05)(N, D)),
        "e_attr": _w((lambda *s: torch.randn(*s, dtype=torch.bfloat16) * 0.4)(E, De)),
        "src": _w((lambda lo, hi, *s: torch.randint(lo, hi, s))(0, N, E).to(torch.int64)),
        "dst": _w((lambda lo, hi, *s: torch.randint(lo, hi, s))(0, N, E).to(torch.int64)),
        "w_msg": _w((lambda *s: torch.randn(*s, dtype=torch.bfloat16) * 0.4)(2 * D + De, D)),
        "w_upd": _w((lambda *s: torch.randn(*s, dtype=torch.bfloat16) * 0.05)(2 * D, D)),
    }

def reference(x, e_attr, src, dst, w_msg, w_upd):
    N, D = x.shape
    m_in = torch.concatenate([x[src], x[dst], e_attr], axis=-1)
    msg = _silu(m_in @ w_msg)
    agg = _segment_sum(msg, dst, N)
    return _silu(torch.concatenate([x, agg], axis=-1) @ w_upd)
```

```asm
; @launch grid=(256,1,1) block=(512,1,1) lds=163840
.amdgcn_target "amdgcn-amd-amdhsa--gfx950"
.text
.globl standalone__mpnn_edge_mlp__graph_kernel
.p2align 8
.type standalone__mpnn_edge_mlp__graph_kernel,@function
standalone__mpnn_edge_mlp__graph_kernel:
    s_getpc_b64 s[72:73]
    s_load_dwordx2 s[4:5], s[0:1], 0
    s_load_dwordx2 s[20:21], s[0:1], 32
    s_load_dwordx2 s[16:17], s[0:1], 24
    s_load_dwordx2 s[12:13], s[0:1], 16
    s_load_dwordx2 s[32:33], s[0:1], 64
    s_load_dwordx2 s[24:25], s[0:1], 40
    s_load_dwordx2 s[8:9], s[0:1], 8
    s_load_dwordx2 s[28:29], s[0:1], 48
    s_cmp_ge_u32 s2, 256
    s_cbranch_scc1 L_end
    v_lshlrev_b32 v208, 7, v0
    v_min_u32 v209, L_code_end-standalone__mpnn_edge_mlp__graph_kernel-8, v208
    global_load_dword v48, v209, s[72:73]
    v_lshrrev_b32 v209, 6, v0
    v_and_b32 v1, 63, v0
    v_readfirstlane_b32 s40, v209
    v_lshrrev_b32 v42, 4, v1
    v_and_b32 v46, 15, v1
    v_lshlrev_b32 v248, 4, v0
    v_lshlrev_b32 v245, 4, v1
    s_lshr_b32 s41, s40, 2
    s_and_b32 s43, s40, 3
    v_lshlrev_b32 v209, 2, v42
    v_xor_b32 v209, v209, v46
    v_lshlrev_b32 v209, 4, v209
    v_lshl_add_u32 v47, v42, 8, v209
    s_lshl_b32 s46, s43, 3
    v_add_u32 v209, s46, v42
    v_xor_b32 v210, v209, v46
    v_and_b32 v210, 15, v210
    v_lshlrev_b32 v222, 4, v210
    v_lshl_or_b32 v60, v209, 8, v222
    v_xor_b32 v61, 1088, v60
    s_lshl_b32 s57, s40, 11
    s_mov_b32 s6, 2560000
    s_mov_b32 s7, 0x20000
    s_mov_b32 s22, 69632
    s_mov_b32 s23, 0x20000
    s_mov_b32 s18, 640000
    s_mov_b32 s19, 0x20000
    s_mov_b32 s14, 640000
    s_mov_b32 s15, 0x20000
    s_mov_b32 s26, 65536
    s_mov_b32 s27, 0x20000
    s_mov_b32 s34, 8388608
    s_mov_b32 s35, 0x20000
    s_cmp_lt_u32 s2, 80
    s_cbranch_scc1 L_bin
    s_cmp_lt_u32 s2, 237
    s_cbranch_scc0 L_ld2
    s_sub_u32 s44, s2, 80
    s_lshl_b32 s44, s44, 1
    s_add_u32 s44, s44, s41
    s_lshl_b32 s65, s44, 13
    s_add_u32 m0, s57, 65536
    s_lshl_b32 s46, s40, 12
    s_mov_b32 s3, 1
    s_waitcnt lgkmcnt(0)
    buffer_load_dwordx4 v60, s[4:7], s65 offen lds
    s_add_u32 m0, s57, 66560
    s_nop 0
    buffer_load_dwordx4 v61, s[4:7], s65 offen lds
    s_mov_b32 m0, s46
    s_nop 0
    buffer_load_dwordx4 v47, s[20:23], s46 offen offset:0 lds
    buffer_load_dwordx4 v47, s[20:23], s46 offen offset:1024 lds
    buffer_load_dwordx4 v47, s[20:23], s46 offen offset:2048 lds
    buffer_load_dwordx4 v47, s[20:23], s46 offen offset:3072 lds
    s_branch L_shadow
L_bin:
    s_mul_i32 s56, s2, 8000
    s_mov_b32 s3, 0
    s_and_b32 s53, s2, -8
    s_add_u32 s53, s53, s40
    s_lshl_b32 s53, s53, 10
    s_waitcnt lgkmcnt(0)
    buffer_load_dwordx4 v[64:67], v248, s[16:19], s56 offen
    buffer_load_dwordx4 v[68:71], v248, s[12:15], s56 offen
    s_load_dword s61, s[32:33], 0
    buffer_load_dwordx4 v[204:207], v245, s[20:23], s53 offen
    v_mov_b32 v84, -1
    v_mov_b32 v85, -1
    v_mov_b32 v86, -1
    v_mov_b32 v87, -1
    v_mov_b32 v83, 0
    v_lshlrev_b32 v80, 2, v0
    ds_write_b128 v248, v[84:87] offset:0
    ds_write_b128 v248, v[84:87] offset:8192
    ds_write_b128 v248, v[84:87] offset:16384
    ds_write_b32 v80, v83 offset:24576
    v_cmp_gt_u32 vcc, 500, v0
    v_lshlrev_b32 v82, 22, v0
    v_lshrrev_b32 v52, 3, v0
    v_mul_u32_u24 v52, 10240, v52
    v_and_b32 v72, 7, v0
    v_lshl_add_u32 v52, v72, 4, v52
    v_mov_b32 v53, 25600
    v_mov_b32 v83, 1
    s_lshl_b32 s46, s2, 7
    s_add_u32 s46, s46, 32768
    s_waitcnt lgkmcnt(0)
    s_add_u32 s61, s61, 1
    s_barrier
    s_mov_b64 exec, vcc
    s_waitcnt vmcnt(2)
    v_and_b32 v76, 255, v64
    v_lshlrev_b32 v54, 2, v76
    v_and_b32 v77, 255, v65
    v_lshlrev_b32 v55, 2, v77
    v_and_b32 v78, 255, v66
    v_lshlrev_b32 v56, 2, v78
    v_and_b32 v79, 255, v67
    v_lshlrev_b32 v57, 2, v79
    ds_add_rtn_u32 v72, v54, v83 offset:24576
    ds_add_rtn_u32 v73, v55, v83 offset:24576
    ds_add_rtn_u32 v74, v56, v83 offset:24576
    ds_add_rtn_u32 v75, v57, v83 offset:24576
    s_waitcnt vmcnt(1)
    v_lshrrev_b32 v64, 8, v64
    v_lshl_or_b32 v64, v68, 6, v64
    v_or_b32 v64, v64, v82
    v_add_u32 v82, 1048576, v82
    v_lshlrev_b32 v76, 5, v76
    v_lshrrev_b32 v65, 8, v65
    v_lshl_or_b32 v65, v69, 6, v65
    v_or_b32 v65, v65, v82
    v_add_u32 v82, 1048576, v82
    v_lshlrev_b32 v77, 5, v77
    v_lshrrev_b32 v66, 8, v66
    v_lshl_or_b32 v66, v70, 6, v66
    v_or_b32 v66, v66, v82
    v_add_u32 v82, 1048576, v82
    v_lshlrev_b32 v78, 5, v78
    v_lshrrev_b32 v67, 8, v67
    v_lshl_or_b32 v67, v71, 6, v67
    v_or_b32 v67, v67, v82
    v_lshlrev_b32 v79, 5, v79
    s_waitcnt lgkmcnt(3)
    v_min_u32 v68, 23, v72
    v_lshrrev_b32 v81, 3, v68
    v_lshl_add_u32 v76, v81, 13, v76
    v_and_b32 v81, 7, v68
    v_lshl_add_u32 v76, v81, 2, v76
    s_waitcnt lgkmcnt(2)
    v_min_u32 v69, 23, v73
    v_lshrrev_b32 v81, 3, v69
    v_lshl_add_u32 v77, v81, 13, v77
    v_and_b32 v81, 7, v69
    v_lshl_add_u32 v77, v81, 2, v77
    s_waitcnt lgkmcnt(1)
    v_min_u32 v70, 23, v74
    v_lshrrev_b32 v81, 3, v70
    v_lshl_add_u32 v78, v81, 13, v78
    v_and_b32 v81, 7, v70
    v_lshl_add_u32 v78, v81, 2, v78
    s_waitcnt lgkmcnt(0)
    v_min_u32 v71, 23, v75
    v_lshrrev_b32 v81, 3, v71
    v_lshl_add_u32 v79, v81, 13, v79
    v_and_b32 v81, 7, v71
    v_lshl_add_u32 v79, v81, 2, v79
    v_max3_u32 v82, v72, v73, v74
    v_max_u32 v82, v82, v75
    v_cmp_le_u32 vcc, 24, v82
    ds_write_b32 v76, v64 offset:0
    ds_write_b32 v77, v65 offset:0
    ds_write_b32 v78, v66 offset:0
    ds_write_b32 v79, v67 offset:0
    s_mov_b64 exec, vcc
    ds_write_b32 v53, v83
    s_mov_b64 exec, -1
    s_waitcnt lgkmcnt(0)
    s_barrier
L_bin_out:
    ds_read_b32 v82, v53
    ds_read2st64_b32 v[64:65], v80 offset0:0 offset1:32
    ds_read_b32 v66, v80 offset:16384
    ds_read2st64_b32 v[68:69], v80 offset0:8 offset1:40
    ds_read_b32 v70, v80 offset:18432
    ds_read2st64_b32 v[84:85], v80 offset0:16 offset1:48
    ds_read_b32 v86, v80 offset:20480
    ds_read2st64_b32 v[88:89], v80 offset0:24 offset1:56
    ds_read_b32 v90, v80 offset:22528
    v_mov_b32 v67, s61
    v_mov_b32 v71, s61
    v_mov_b32 v87, s61
    v_mov_b32 v91, s61
    s_waitcnt lgkmcnt(8)
    v_readfirstlane_b32 s44, v82
    s_nop 0
    s_cmp_lg_u32 s44, 0
    s_cbranch_scc1 L_bin_ovf
    s_waitcnt lgkmcnt(6)
    buffer_store_dwordx4 v[64:67], v52, s[32:35], s46 offen sc1
    s_add_u32 s46, s46, 655360
    s_waitcnt lgkmcnt(4)
    buffer_store_dwordx4 v[68:71], v52, s[32:35], s46 offen sc1
    s_add_u32 s46, s46, 655360
    s_waitcnt lgkmcnt(2)
    buffer_store_dwordx4 v[84:87], v52, s[32:35], s46 offen sc1
    s_add_u32 s46, s46, 655360
    s_waitcnt lgkmcnt(0)
    buffer_store_dwordx4 v[88:91], v52, s[32:35], s46 offen sc1
    s_branch L_shadow0
L_ld2:
    s_sub_u32 s65, s2, 237
    s_lshl_b32 s46, s40, 10
    s_lshl_b32 s44, s65, 13
    s_add_u32 s44, s44, s46
    s_mov_b32 m0, s46
    s_mov_b32 s3, 2
    s_waitcnt lgkmcnt(0)
    buffer_load_dwordx4 v47, s[24:27], s44 offen lds
L_shadow:
    s_load_dword s61, s[32:33], 0
L_shadow0:
    v_mov_b32 v128, 0
    v_mov_b32 v129, 0
    v_mov_b32 v130, 0
    v_mov_b32 v131, 0
    v_add_u32 v136, 92160, v248
    v_cmp_gt_u32 vcc, 510, v0
    v_mov_b32 v132, 0x7fffff
    ds_write_b128 v136, v[128:131] offset:0
    ds_write_b128 v136, v[128:131] offset:8192
    ds_write_b128 v136, v[128:131] offset:16384
    ds_write_b128 v136, v[128:131] offset:24576
    ds_write_b128 v136, v[128:131] offset:32768
    ds_write_b128 v136, v[128:131] offset:40960
    s_cmp_eq_u32 s41, 0
    s_cbranch_scc0 L_li0
    ds_write_b128 v136, v[128:131] offset:49152
L_li0:
    v_cndmask_b32 v132, 0, v132, vcc
    v_mov_b32 v133, v132
    v_mov_b32 v134, v132
    v_mov_b32 v135, v132
    ds_write_b128 v136, v[132:135] offset:53248
    s_mov_b32 s10, 5120000
    s_mov_b32 s11, 0x20000
    s_mov_b32 s30, 2560000
    s_mov_b32 s31, 0x20000
    s_mov_b32 s38, 2560000
    s_mov_b32 s39, 0x20000
    s_add_u32 s36, s32, 3211264
    s_addc_u32 s37, s33, 0
    s_mov_b32 s62, 0xbfb8aa3b
    s_mov_b32 s63, 0xbfb8aa3b
    s_lshl_b32 s70, s2, 8
    v_lshrrev_b32 v40, 5, v1
    v_and_b32 v41, 31, v1
    v_and_b32 v43, 1, v42
    v_bfe_u32 v44, v1, 2, 2
    v_and_b32 v49, 1, v1
    v_bfe_u32 v50, v1, 1, 1
    v_and_b32 v51, 12, v1
    v_lshlrev_b32 v62, 2, v1
    v_xor_b32 v223, 64, v222
    s_lshl_b32 s46, s40, 2
    v_add_u32 v208, s46, v42
    v_xor_b32 v209, v208, v46
    v_and_b32 v209, 15, v209
    v_lshlrev_b32 v209, 4, v209
    v_lshl_or_b32 v224, v208, 17, v209
    v_add_u32 v225, 1638400, v224
    s_cmp_ge_u32 s40, 5
    s_cselect_b32 s46, 2555904, 0
    v_subrev_u32 v224, s46, v224
    s_mul_i32 s74, s2, 80
    s_mul_i32 s44, s40, 10
    s_add_u32 s74, s74, s44
    s_lshl_b32 s74, s74, 7
    s_add_u32 s74, s74, 32768
    v_lshrrev_b32 v208, 3, v1
    v_add_u32 v208, s44, v208
    s_add_u32 s44, s44, 8
    v_add_u32 v209, s44, v40
    v_mul_u32_u24 v230, 2000, v208
    v_mul_u32_u24 v231, 2000, v209
    s_mov_b32 s68, 0x88888888
    s_mov_b32 s69, 0x88888888
    s_mov_b32 s76, 0x000f000f
    s_mov_b32 s77, 0x000f000f
    s_mov_b32 s78, 0xcccccccc
    s_mov_b32 s79, 0xcccccccc
    s_lshl_b32 s45, s43, 6
    s_mul_i32 s66, s41, 13312
    s_add_u32 s66, s66, s45
    s_add_u32 s66, s66, 65536
    s_lshl_b32 s44, s41, 12
    s_add_u32 s44, s44, 145408
    s_add_u32 s45, s45, s44
    v_lshl_add_u32 v242, v42, 4, s45
    v_xor_b32 v243, v49, v43
    v_lshlrev_b32 v243, 4, v243
    s_mov_b32 s50, 416
    s_mov_b32 s64, 0
    s_mov_b32 s42, s3
    v_mov_b32 v247, 0x3f80
    s_cmp_eq_u32 s3, 1
    s_cbranch_scc0 L_cl
    s_lshl_b32 s46, s43, 2
    v_lshl_add_u32 v208, v49, 1, v43
    v_add_u32 v208, s46, v208
    v_xor_b32 v208, v208, v51
    v_lshlrev_b32 v208, 4, v208
    v_lshl_add_u32 v208, v50, 3, v208
    v_lshl_add_u32 v212, v40, 3, v44
    v_lshl_add_u32 v52, v212, 8, v208
    v_xor_b32 v209, v46, v40
    v_lshlrev_b32 v209, 4, v209
    v_lshl_add_u32 v209, v41, 8, v209
    s_lshl_b32 s44, s41, 13
    s_add_u32 s45, s44, 65536
    v_add_u32 v144, s45, v209
    v_xor_b32 v145, 32, v144
    v_xor_b32 v146, 64, v144
    v_xor_b32 v147, 96, v144
    v_xor_b32 v148, 128, v144
    v_xor_b32 v149, 160, v144
    v_xor_b32 v150, 192, v144
    v_xor_b32 v151, 224, v144
    v_lshl_add_u32 v209, v40, 1, s46
    v_xor_b32 v209, v209, v46
    v_lshlrev_b32 v209, 4, v209
    v_lshl_add_u32 v209, v41, 8, v209
    v_add_u32 v53, s44, v209
    v_xor_b32 v54, 16, v53
    v_add_u32 v55, s57, v245
L_cl:
    s_lshl_b32 s53, s40, 10
    s_add_u32 m0, s53, 153600
    s_lshl_b32 s52, s40, 12
    buffer_load_dwordx4 v224, s[4:7], s70 offen lds
    s_cmp_lt_u32 s40, 2
    s_cbranch_scc0 L_ld_w3
    s_add_u32 m0, s53, 161792
    s_nop 0
    buffer_load_dwordx4 v225, s[4:7], s70 offen lds
    s_branch L_ld_w2
L_ld_w3:
    s_min_u32 s53, s53, 5120
    s_add_u32 m0, s53, 86016
    s_add_u32 s53, s53, 63488
    buffer_load_dwordx4 v47, s[20:23], s53 offen lds
L_ld_w2:
    s_add_u32 s52, s52, 32768
    s_mov_b32 m0, s52
    s_nop 0
    buffer_load_dwordx4 v47, s[20:23], s52 offen offset:0 lds
    buffer_load_dwordx4 v47, s[20:23], s52 offen offset:1024 lds
    buffer_load_dwordx4 v47, s[20:23], s52 offen offset:2048 lds
    buffer_load_dwordx4 v47, s[20:23], s52 offen offset:3072 lds
    s_cmp_eq_u32 s3, 1
    s_cbranch_scc0 L_role02
    s_waitcnt vmcnt(6) lgkmcnt(0)
    s_add_u32 s61, s61, 1
    s_barrier
    ds_read_b128 v[112:115], v144
    ds_read_b64_tr_b16 v[64:65], v52 offset:0
    ds_read_b64_tr_b16 v[66:67], v52 offset:1024
    ds_read_b128 v[116:119], v145
    ds_read_b64_tr_b16 v[68:69], v52 offset:4096
    ds_read_b64_tr_b16 v[70:71], v52 offset:5120
    ds_read_b128 v[120:123], v146
    ds_read_b64_tr_b16 v[72:73], v52 offset:8192
    ds_read_b64_tr_b16 v[74:75], v52 offset:9216
    ds_read_b128 v[124:127], v147
    ds_read_b64_tr_b16 v[76:77], v52 offset:12288
    ds_read_b64_tr_b16 v[78:79], v52 offset:13312
    s_waitcnt lgkmcnt(9)
    v_mfma_f32_32x32x16_bf16 v[96:111], v[64:67], v[112:115], 0
    ds_read_b128 v[128:131], v148
    ds_read_b64_tr_b16 v[80:81], v52 offset:16384
    ds_read_b64_tr_b16 v[82:83], v52 offset:17408
    s_waitcnt lgkmcnt(9)
    v_mfma_f32_32x32x16_bf16 v[96:111], v[68:71], v[116:119], v[96:111]
    ds_read_b128 v[132:135], v149
    ds_read_b64_tr_b16 v[84:85], v52 offset:20480
    ds_read_b64_tr_b16 v[86:87], v52 offset:21504
    s_waitcnt lgkmcnt(9)
    v_mfma_f32_32x32x16_bf16 v[96:111], v[72:75], v[120:123], v[96:111]
    ds_read_b128 v[136:139], v150
    ds_read_b64_tr_b16 v[88:89], v52 offset:24576
    ds_read_b64_tr_b16 v[90:91], v52 offset:25600
    s_waitcnt lgkmcnt(9)
    v_mfma_f32_32x32x16_bf16 v[96:111], v[76:79], v[124:127], v[96:111]
    ds_read_b128 v[140:143], v151
    ds_read_b64_tr_b16 v[92:93], v52 offset:28672
    ds_read_b64_tr_b16 v[94:95], v52 offset:29696
    s_waitcnt lgkmcnt(9)
    v_mfma_f32_32x32x16_bf16 v[96:111], v[80:83], v[128:131], v[96:111]
    s_waitcnt lgkmcnt(6)
    v_mfma_f32_32x32x16_bf16 v[96:111], v[84:87], v[132:135], v[96:111]
    s_waitcnt lgkmcnt(3)
    v_mfma_f32_32x32x16_bf16 v[96:111], v[88:91], v[136:139], v[96:111]
    s_waitcnt lgkmcnt(0)
    v_mfma_f32_32x32x16_bf16 v[96:111], v[92:95], v[140:143], v[96:111]
    s_barrier
    s_nop 10
    v_mul_f32 v96, s62, v96
    v_mul_f32 v97, s62, v97
    v_cvt_pk_bf16_f32 v172, v96, v97
    v_mul_f32 v98, s62, v98
    v_mul_f32 v99, s62, v99
    v_cvt_pk_bf16_f32 v173, v98, v99
    v_mul_f32 v100, s62, v100
    v_mul_f32 v101, s62, v101
    v_cvt_pk_bf16_f32 v174, v100, v101
    v_mul_f32 v102, s62, v102
    v_mul_f32 v103, s62, v103
    v_cvt_pk_bf16_f32 v175, v102, v103
    v_mul_f32 v104, s62, v104
    v_mul_f32 v105, s62, v105
    v_cvt_pk_bf16_f32 v176, v104, v105
    v_mul_f32 v106, s62, v106
    v_mul_f32 v107, s62, v107
    v_cvt_pk_bf16_f32 v177, v106, v107
    v_mul_f32 v108, s62, v108
    v_mul_f32 v109, s62, v109
    v_cvt_pk_bf16_f32 v178, v108, v109
    v_mul_f32 v110, s62, v110
    v_mul_f32 v111, s62, v111
    v_cvt_pk_bf16_f32 v179, v110, v111
    ds_write_b128 v53, v[172:175]
    ds_write_b128 v54, v[176:179]
    s_waitcnt lgkmcnt(0)
    s_barrier
    ds_read_b128 v[172:175], v55
    ds_read_b128 v[176:179], v55 offset:1024
    buffer_load_dwordx4 v[204:207], v245, s[32:35], s74 offen sc1
    buffer_load_dword v244, v62, s[32:35], s74 offen offset:1024 sc1
    s_waitcnt lgkmcnt(1)
    buffer_store_dwordx4 v[172:175], v60, s[36:39], s65 offen sc1
    s_waitcnt lgkmcnt(0)
    buffer_store_dwordx4 v[176:179], v61, s[36:39], s65 offen sc1
    s_waitcnt vmcnt(2)
    s_cmp_eq_u32 s41, 0
    s_cbranch_scc1 L_common
    s_waitcnt vmcnt(0)
    s_cmp_eq_u32 s42, 0
    s_cbranch_scc1 L_arr3
    s_mov_b32 s42, 0
    s_mov_b64 exec, 1
    v_mov_b32 v212, 153584
    v_mov_b32 v208, 1
    ds_add_rtn_u32 v208, v212, v208
    s_sub_u32 s53, s2, 80
    s_lshl_b32 s53, s53, 7
    s_add_u32 s53, s53, 4096
    v_mov_b32 v209, s61
    s_waitcnt lgkmcnt(0)
    v_readfirstlane_b32 s52, v208
    s_nop 0
    s_cmp_eq_u32 s52, 7
    s_cbranch_scc0 L_arrx3
    buffer_store_dword v209, v1, s[32:35], s53 offen sc1
L_arrx3:
    s_mov_b64 exec, -1
L_arr3:
L_common:
    s_mov_b32 s65, 200000
L_poll:
    v_cmp_ne_u32 vcc, s61, v244
    v_cmp_ne_u32 s[44:45], s61, v207
    s_and_b64 vcc, vcc, s[68:69]
    s_or_b64 s[48:49], vcc, s[44:45]
    s_cbranch_scc1 L_repoll
    v_cndmask_b32 v244, v244, -1, s[68:69]
    v_min_i32 v208, v204, v244
    v_cmp_eq_u32 vcc, -2, v208
    s_cbranch_vccnz L_markov
L_count:
    v_lshlrev_b32 v164, 4, v204
    v_ashrrev_i32 v226, 31, v204
    v_add_u32 v208, 1, v226
    v_lshlrev_b32 v145, v164, v208
    v_lshlrev_b32 v165, 4, v205
    v_ashrrev_i32 v227, 31, v205
    v_add_u32 v208, 1, v227
    v_lshl_add_u32 v146, v208, v165, v145
    v_lshlrev_b32 v166, 4, v206
    v_ashrrev_i32 v228, 31, v206
    v_add_u32 v208, 1, v228
    v_lshl_add_u32 v147, v208, v166, v146
    v_lshlrev_b32 v167, 4, v244
    v_ashrrev_i32 v229, 31, v244
    v_add_u32 v208, 1, v229
    v_lshl_add_u32 v148, v208, v167, v147
    v_mov_b32 v210, 153568
    s_mov_b32 s51, 0
    v_add_u32_dpp v209, v148, v148 row_shr:1 row_mask:0xf bank_mask:0xf bound_ctrl:0
    s_nop 1
    v_add_u32_dpp v209, v209, v209 row_shr:2 row_mask:0xf bank_mask:0xf bound_ctrl:0
    s_nop 1
    v_add_u32_dpp v209, v209, v209 row_shr:4 row_mask:0xf bank_mask:0xf bound_ctrl:0
    s_nop 1
    v_add_u32_dpp v209, v209, v209 row_shr:8 row_mask:0xf bank_mask:0xf bound_ctrl:0
    s_nop 1
    v_add_u32_dpp v209, v209, v209 row_bcast:15 row_mask:0xa bank_mask:0xf
    s_nop 1
    v_add_u32_dpp v209, v209, v209 row_bcast:31 row_mask:0xc bank_mask:0xf
    s_mov_b32 exec_lo, 0
    s_brev_b32 exec_hi, 1
    ds_add_rtn_u32 v211, v210, v209
    s_mov_b64 exec, -1
    v_sub_u32 v144, v209, v148
    v_add_u32 v145, v144, v145
    v_add_u32 v146, v144, v146
    v_add_u32 v147, v144, v147
    s_waitcnt lgkmcnt(0)
    v_readlane_b32 s46, v211, 63
    s_nop 1
    v_add_u32 v144, s46, v144
    v_add_u32 v145, s46, v145
    v_add_u32 v146, s46, v146
    v_add_u32 v147, s46, v147
    v_bfe_u32 v144, v144, v164, 16
    v_or_b32 v226, v226, v144
    v_bfe_u32 v145, v145, v165, 16
    v_or_b32 v227, v227, v145
    v_bfe_u32 v146, v146, v166, 16
    v_or_b32 v228, v228, v146
    v_bfe_u32 v147, v147, v167, 16
    v_or_b32 v229, v229, v147
L_round:
    v_mov_b32 v214, 92160
    v_mov_b32 v213, 145408
    v_cmp_gt_u32 vcc, s50, v226
    s_nop 0
    s_and_b64 exec, vcc, vcc
    s_cbranch_scc0 L_wskip0
    v_bfe_u32 v208, v204, 6, 14
    v_lshrrev_b32 v209, 20, v204
    v_add_u32 v209, v209, v230
    v_and_b32 v210, 1, v204
    v_lshl_add_u32 v211, v210, 9, v226
    v_lshl_add_u32 v211, v211, 3, v213
    v_mad_u32_u24 v210, v210, s50, v226
    v_and_or_b32 v215, v204, 62, v214
    v_lshlrev_b32 v212, 2, v226
    v_and_b32 v212, 0x30, v212
    v_xor_b32 v215, v215, v212
    v_lshl_add_u32 v215, v210, 6, v215
    ds_write_b64 v211, v[208:209]
    ds_write_b16 v215, v247
L_wskip0:
    s_mov_b64 exec, -1
    v_cmp_gt_u32 vcc, s50, v227
    s_nop 0
    s_and_b64 exec, vcc, vcc
    s_cbranch_scc0 L_wskip1
    v_bfe_u32 v208, v205, 6, 14
    v_lshrrev_b32 v209, 20, v205
    v_add_u32 v209, v209, v230
    v_and_b32 v210, 1, v205
    v_lshl_add_u32 v211, v210, 9, v227
    v_lshl_add_u32 v211, v211, 3, v213
    v_mad_u32_u24 v210, v210, s50, v227
    v_and_or_b32 v215, v205, 62, v214
    v_lshlrev_b32 v212, 2, v227
    v_and_b32 v212, 0x30, v212
    v_xor_b32 v215, v215, v212
    v_lshl_add_u32 v215, v210, 6, v215
    ds_write_b64 v211, v[208:209]
    ds_write_b16 v215, v247
L_wskip1:
    s_mov_b64 exec, -1
    v_cmp_gt_u32 vcc, s50, v229
    s_nop 0
    s_and_b64 exec, vcc, vcc
    s_cbranch_scc0 L_wskip3
    v_bfe_u32 v208, v244, 6, 14
    v_lshrrev_b32 v209, 20, v244
    v_add_u32 v209, v209, v231
    v_and_b32 v210, 1, v244
    v_lshl_add_u32 v211, v210, 9, v229
    v_lshl_add_u32 v211, v211, 3, v213
    v_mad_u32_u24 v210, v210, s50, v229
    v_and_or_b32 v215, v244, 62, v214
    v_lshlrev_b32 v212, 2, v229
    v_and_b32 v212, 0x30, v212
    v_xor_b32 v215, v215, v212
    v_lshl_add_u32 v215, v210, 6, v215
    ds_write_b64 v211, v[208:209]
    ds_write_b16 v215, v247
L_wskip3:
    s_mov_b64 exec, -1
    v_cmp_gt_u32 vcc, s50, v228
    s_nop 0
    s_and_b64 exec, vcc, vcc
    s_cbranch_scc0 L_wskip2
    v_bfe_u32 v208, v206, 6, 14
    v_lshrrev_b32 v209, 20, v206
    v_add_u32 v209, v209, v230
    v_and_b32 v210, 1, v206
    v_lshl_add_u32 v211, v210, 9, v228
    v_lshl_add_u32 v211, v211, 3, v213
    v_mad_u32_u24 v210, v210, s50, v228
    v_and_or_b32 v215, v206, 62, v214
    v_lshlrev_b32 v212, 2, v228
    v_and_b32 v212, 0x30, v212
    v_xor_b32 v215, v215, v212
    v_lshl_add_u32 v215, v210, 6, v215
    ds_write_b64 v211, v[208:209]
    ds_write_b16 v215, v247
L_wskip2:
    s_mov_b64 exec, -1
    s_waitcnt vmcnt(0)
    s_cmp_eq_u32 s42, 0
    s_cbranch_scc1 L_arr0
    s_mov_b32 s42, 0
    s_mov_b64 exec, 1
    v_mov_b32 v212, 153584
    v_mov_b32 v208, 1
    ds_add_rtn_u32 v208, v212, v208
    s_sub_u32 s53, s2, 80
    s_lshl_b32 s53, s53, 7
    s_add_u32 s53, s53, 4096
    v_mov_b32 v209, s61
    s_waitcnt lgkmcnt(0)
    v_readfirstlane_b32 s52, v208
    s_nop 0
    s_cmp_eq_u32 s52, 7
    s_cbranch_scc0 L_arrx0
    buffer_store_dword v209, v1, s[32:35], s53 offen sc1
L_arrx0:
    s_mov_b64 exec, -1
L_arr0:
    v_mov_b32 v212, 153568
    s_waitcnt lgkmcnt(0)
    s_barrier
    ds_read_b128 v[188:191], v242 offset:0
    ds_read_b128 v[192:195], v242 offset:256
    ds_read_b128 v[196:199], v242 offset:512
    ds_read_b128 v[200:203], v242 offset:768
    ds_read_b128 v[172:175], v212
    s_waitcnt lgkmcnt(4)
    v_cndmask_b32 v189, v189, v191, s[78:79]
    v_lshl_or_b32 v189, v189, 5, v243
    s_add_u32 m0, s66, 0
    s_mov_b64 exec, s[76:77]
    buffer_load_dwordx4 v189, s[8:11], 0 offen lds
    s_mov_b64 exec, -1
    s_waitcnt lgkmcnt(3)
    v_cndmask_b32 v193, v193, v195, s[78:79]
    v_lshl_or_b32 v193, v193, 5, v243
    s_add_u32 m0, s66, 1024
    s_mov_b64 exec, s[76:77]
    buffer_load_dwordx4 v193, s[8:11], 0 offen lds
    s_mov_b64 exec, -1
    s_waitcnt lgkmcnt(2)
    v_cndmask_b32 v197, v197, v199, s[78:79]
    v_lshl_or_b32 v197, v197, 5, v243
    s_add_u32 m0, s66, 2048
    s_mov_b64 exec, s[76:77]
    buffer_load_dwordx4 v197, s[8:11], 0 offen lds
    s_mov_b64 exec, -1
    s_waitcnt lgkmcnt(1)
    v_cndmask_b32 v201, v201, v203, s[78:79]
    v_lshl_or_b32 v201, v201, 5, v243
    s_add_u32 m0, s66, 3072
    s_mov_b64 exec, s[76:77]
    buffer_load_dwordx4 v201, s[8:11], 0 offen lds
    s_mov_b64 exec, -1
    v_lshl_or_b32 v188, v188, 8, v222
    v_lshl_or_b32 v190, v190, 8, v223
    v_lshl_or_b32 v192, v192, 8, v222
    v_lshl_or_b32 v194, v194, 8, v223
    v_lshl_or_b32 v196, v196, 8, v222
    v_lshl_or_b32 v198, v198, 8, v223
    v_subrev_u32 v226, s50, v226
    v_subrev_u32 v227, s50, v227
    v_subrev_u32 v228, s50, v228
    v_subrev_u32 v229, s50, v229
    s_waitcnt lgkmcnt(0)
    s_cmp_lg_u32 s51, 0
    s_cbranch_scc1 L_havetot
    v_readfirstlane_b32 s52, v172
    s_mov_b32 s51, 1
    s_lshr_b32 s53, s52, 16
    s_and_b32 s52, s52, 0xffff
    s_cmp_lg_u32 s64, 0
    s_cbranch_scc1 L_havetot
    v_readfirstlane_b32 s58, v173
    v_readfirstlane_b32 s59, v174
    v_readfirstlane_b32 s60, v175
    s_lshl_b32 s46, s43, 2
    v_lshl_add_u32 v45, v43, 1, v50
    v_add_u32 v208, s46, v45
    v_xor_b32 v208, v208, v51
    v_lshlrev_b32 v208, 4, v208
    v_lshl_add_u32 v208, v49, 3, v208
    v_lshl_add_u32 v212, v40, 3, v44
    v_lshl_add_u32 v211, v212, 8, v208
    v_add_u32 v214, 88064, v211
    ds_read_b64_tr_b16 v[64:65], v211 offset:32768
    ds_read_b64_tr_b16 v[66:67], v211 offset:33792
    ds_read_b64_tr_b16 v[68:69], v211 offset:36864
    ds_read_b64_tr_b16 v[70:71], v211 offset:37888
    ds_read_b64_tr_b16 v[72:73], v211 offset:40960
    ds_read_b64_tr_b16 v[74:75], v211 offset:41984
    ds_read_b64_tr_b16 v[76:77], v211 offset:45056
    ds_read_b64_tr_b16 v[78:79], v211 offset:46080
    v_and_b32 v208, 0x13, v41
    v_and_b32 v209, 4, v41
    v_lshl_or_b32 v208, v209, 1, v208
    v_bfe_u32 v209, v41, 3, 1
    v_lshl_or_b32 v208, v209, 2, v208
    v_min_u32 v208, 19, v208
    s_mul_i32 s44, s41, 20
    v_add_u32 v208, s44, v208
    v_xor_b32 v209, v208, v40
    v_and_b32 v209, 15, v209
    v_lshlrev_b32 v209, 4, v209
    v_lshl_add_u32 v209, v208, 8, v209
    v_add_u32 v144, 153600, v209
    v_xor_b32 v145, 32, v144
    v_xor_b32 v146, 64, v144
    v_xor_b32 v147, 96, v144
    v_xor_b32 v148, 128, v144
    v_xor_b32 v149, 160, v144
    v_xor_b32 v150, 192, v144
    v_xor_b32 v151, 224, v144
    ds_read_b128 v[112:115], v144
    ds_read_b128 v[116:119], v145
    ds_read_b128 v[120:123], v146
    ds_read_b128 v[124:127], v147
    s_waitcnt lgkmcnt(3)
    v_mfma_f32_32x32x16_bf16 v[96:111], v[112:115], v[64:67], 0
    ds_read_b128 v[128:131], v148
    ds_read_b64_tr_b16 v[80:81], v211 offset:49152
    ds_read_b64_tr_b16 v[82:83], v211 offset:50176
    s_mul_i32 s75, s40, 2816
    s_add_u32 s75, s75, 4096
    v_min_u32 v63, 21, v1
    v_lshlrev_b32 v63, 7, v63
    s_lshl_b32 s67, s40, 13
    s_add_u32 s67, s67, 3145728
    s_waitcnt lgkmcnt(5)
    v_mfma_f32_32x32x16_bf16 v[96:111], v[116:119], v[68:71], v[96:111]
    ds_read_b128 v[132:135], v149
    ds_read_b64_tr_b16 v[84:85], v211 offset:53248
    ds_read_b64_tr_b16 v[86:87], v211 offset:54272
    s_lshl_b32 s46, s40, 1
    v_add_u32 v210, s46, v40
    v_xor_b32 v212, v210, v42
    v_lshlrev_b32 v212, 4, v212
    v_lshl_or_b32 v212, v43, 3, v212
    v_mov_b32 v208, v46
    s_waitcnt lgkmcnt(7)
    v_mfma_f32_32x32x16_bf16 v[96:111], v[120:123], v[72:75], v[96:111]
    ds_read_b128 v[136:139], v150
    ds_read_b64_tr_b16 v[88:89], v211 offset:57344
    ds_read_b64_tr_b16 v[90:91], v211 offset:58368
    v_xor_b32 v209, v208, v42
    v_and_b32 v209, 15, v209
    v_lshlrev_b32 v209, 4, v209
    v_lshl_add_u32 v209, v208, 8, v209
    v_add_u32 v232, 153600, v209
    v_xor_b32 v238, v212, v232
    s_waitcnt lgkmcnt(9)
    v_mfma_f32_32x32x16_bf16 v[96:111], v[124:127], v[76:79], v[96:111]
    ds_read_b128 v[140:143], v151
    ds_read_b64_tr_b16 v[92:93], v211 offset:61440
    ds_read_b64_tr_b16 v[94:95], v211 offset:62464
    v_lshlrev_b32 v209, 4, v208
    v_lshl_add_u32 v209, v42, 9, v209
    v_add_u32 v235, 92160, v209
    v_add_u32 v208, 16, v46
    v_xor_b32 v209, v208, v42
    v_and_b32 v209, 15, v209
    s_waitcnt lgkmcnt(9)
    v_mfma_f32_32x32x16_bf16 v[96:111], v[128:131], v[80:83], v[96:111]
    ds_read_b64_tr_b16 v[12:13], v214 offset:0
    ds_read_b64_tr_b16 v[14:15], v214 offset:1024
    v_lshlrev_b32 v209, 4, v209
    v_lshl_add_u32 v209, v208, 8, v209
    v_add_u32 v233, 153600, v209
    v_xor_b32 v239, v212, v233
    v_lshlrev_b32 v209, 4, v208
    v_lshl_add_u32 v209, v42, 9, v209
    s_waitcnt lgkmcnt(8)
    v_mfma_f32_32x32x16_bf16 v[96:111], v[132:135], v[84:87], v[96:111]
    v_cmp_le_u32 vcc, 20, v208
    v_add_u32 v213, 118464, v209
    v_add_u32 v209, 92160, v209
    v_cndmask_b32 v236, v209, v213, vcc
    v_add_u32 v208, 32, v46
    v_min_u32 v208, 39, v208
    s_waitcnt lgkmcnt(5)
    v_mfma_f32_32x32x16_bf16 v[96:111], v[136:139], v[88:91], v[96:111]
    v_xor_b32 v209, v208, v42
    v_and_b32 v209, 15, v209
    v_lshlrev_b32 v209, 4, v209
    v_lshl_add_u32 v209, v208, 8, v209
    v_add_u32 v234, 153600, v209
    v_xor_b32 v240, v212, v234
    s_waitcnt lgkmcnt(2)
    v_mfma_f32_32x32x16_bf16 v[96:111], v[140:143], v[92:95], v[96:111]
    buffer_load_dword v48, v63, s[32:35], s75 offen sc1
    v_lshlrev_b32 v209, 4, v208
    v_lshl_add_u32 v209, v42, 9, v209
    v_add_u32 v237, 118464, v209
    s_lshl_b32 s57, s41, 15
    s_lshl_b32 s46, s43, 11
    s_add_u32 s57, s57, s46
    s_mov_b32 s65, 200000
    s_waitcnt vmcnt(0) lgkmcnt(0)
L_pollf:
    v_cmp_ne_u32 vcc, s61, v48
    s_cbranch_vccnz L_repollf
L_havetot:
    s_mov_b32 m0, s57
    s_barrier
    buffer_load_dwordx4 v188, s[36:39], 0 offen sc1 lds
    s_add_u32 m0, s57, 1024
    s_nop 0
    buffer_load_dwordx4 v190, s[36:39], 0 offen sc1 lds
    s_max_i32 s44, s52, s53
    s_cmp_eq_u32 s41, 0
    s_cselect_b32 s45, s52, s53
    s_mov_b32 s47, s45
    s_max_i32 s44, s44, 1
    s_add_u32 s44, s44, 31
    s_lshr_b32 s44, s44, 5
    s_min_u32 s55, s44, 13
    s_max_i32 s45, s45, 1
    s_add_u32 s45, s45, 31
    s_lshr_b32 s45, s45, 5
    s_min_u32 s54, s45, 13
    s_lshl_b32 s46, s54, 5
    s_sub_i32 s47, s47, s46
    s_min_i32 s56, s52, s53
    s_sub_i32 s52, s52, 416
    s_sub_i32 s53, s53, 416
    s_sub_u32 s55, s55, s54
    s_cmp_lg_u32 s64, 0
    s_cbranch_scc1 L_consts_done
    s_mov_b32 s64, 1
    s_lshl_b32 s46, s43, 2
    v_and_b32 v210, 24, v41
    v_lshl_or_b32 v208, v49, 2, v210
    v_bfe_u32 v211, v41, 1, 2
    v_or_b32 v208, v208, v211
    v_add_u32 v209, s46, v40
    v_xor_b32 v209, v209, v208
    v_and_b32 v209, 15, v209
    v_lshlrev_b32 v209, 4, v209
    v_lshl_add_u32 v209, v208, 8, v209
    s_lshl_b32 s44, s41, 15
    v_add_u32 v216, s44, v209
    v_xor_b32 v217, 32, v216
    v_xor_b32 v209, v50, v40
    v_lshlrev_b32 v209, 4, v209
    v_lshl_or_b32 v209, v49, 5, v209
    v_lshl_or_b32 v209, v211, 8, v209
    v_lshl_or_b32 v209, v210, 3, v209
    s_and_b32 s44, s66, -256
    v_add_u32 v241, s44, v209
    s_mul_i32 s44, s41, 26624
    s_add_u32 s44, s44, 92160
    v_xor_b32 v208, v44, v40
    v_lshlrev_b32 v208, 4, v208
    v_lshl_add_u32 v208, v41, 6, v208
    v_add_u32 v218, s44, v208
    v_xor_b32 v219, 32, v218
    v_xor_b32 v208, v45, v40
    v_lshlrev_b32 v208, 4, v208
    v_lshl_add_u32 v208, v49, 3, v208
    v_lshl_add_u32 v209, v40, 2, v44
    v_lshl_add_u32 v208, v209, 6, v208
    v_add_u32 v220, s44, v208
    v_xor_b32 v221, 544, v220
    v_add_u32 v246, 4096, v245
    v_pk_mul_f32 v[96:97], v[96:97], s[62:63]
    v_cvt_pk_bf16_f32 v16, v96, v97
    v_pk_mul_f32 v[98:99], v[98:99], s[62:63]
    v_cvt_pk_bf16_f32 v17, v98, v99
    v_pk_mul_f32 v[100:101], v[100:101], s[62:63]
    v_cvt_pk_bf16_f32 v18, v100, v101
    v_pk_mul_f32 v[102:103], v[102:103], s[62:63]
    v_cvt_pk_bf16_f32 v19, v102, v103
    v_pk_mul_f32 v[104:105], v[104:105], s[62:63]
    v_cvt_pk_bf16_f32 v20, v104, v105
    v_pk_mul_f32 v[106:107], v[106:107], s[62:63]
    v_cvt_pk_bf16_f32 v21, v106, v107
    v_pk_mul_f32 v[108:109], v[108:109], s[62:63]
    v_cvt_pk_bf16_f32 v22, v108, v109
    v_pk_mul_f32 v[110:111], v[110:111], s[62:63]
    v_cvt_pk_bf16_f32 v23, v110, v111
    v_lshlrev_b32 v208, 16, v12
    v_and_b32 v209, 0xffff0000, v12
    v_pk_mul_f32 v[208:209], v[208:209], s[62:63]
    v_cvt_pk_bf16_f32 v12, v208, v209
    v_lshlrev_b32 v208, 16, v13
    v_and_b32 v209, 0xffff0000, v13
    v_pk_mul_f32 v[208:209], v[208:209], s[62:63]
    v_cvt_pk_bf16_f32 v13, v208, v209
    v_lshlrev_b32 v208, 16, v14
    v_and_b32 v209, 0xffff0000, v14
    v_pk_mul_f32 v[208:209], v[208:209], s[62:63]
    v_cvt_pk_bf16_f32 v14, v208, v209
    v_lshlrev_b32 v208, 16, v15
    v_and_b32 v209, 0xffff0000, v15
    v_pk_mul_f32 v[208:209], v[208:209], s[62:63]
    v_cvt_pk_bf16_f32 v15, v208, v209
    v_lshrrev_b32 v208, 1, v41
    v_lshlrev_b32 v209, 2, v40
    v_sub_u32 v208, v208, v209
    v_lshlrev_b32 v209, 4, v41
    v_lshlrev_b32 v209, v209, v247
    v_cmp_eq_u32 vcc, 0, v208
    v_mov_b32 v24, 0
    v_mov_b32 v25, 0
    v_cndmask_b32 v4, 0, v209, vcc
    v_cmp_eq_u32 vcc, 1, v208
    v_mov_b32 v26, 0
    v_mov_b32 v27, 0
    v_cndmask_b32 v5, 0, v209, vcc
    v_cmp_eq_u32 vcc, 2, v208
    v_mov_b32 v28, 0
    v_mov_b32 v29, 0
    v_cndmask_b32 v6, 0, v209, vcc
    v_cmp_eq_u32 vcc, 3, v208
    v_mov_b32 v30, 0
    v_mov_b32 v31, 0
    v_cndmask_b32 v7, 0, v209, vcc
    v_cmp_eq_u32 vcc, 8, v208
    v_mov_b32 v32, 0
    v_mov_b32 v33, 0
    v_cndmask_b32 v8, 0, v209, vcc
    v_cmp_eq_u32 vcc, 9, v208
    v_mov_b32 v34, 0
    v_mov_b32 v35, 0
    v_cndmask_b32 v9, 0, v209, vcc
    v_cmp_eq_u32 vcc, 10, v208
    v_mov_b32 v36, 0
    v_mov_b32 v37, 0
    v_cndmask_b32 v10, 0, v209, vcc
    v_cmp_eq_u32 vcc, 11, v208
    v_mov_b32 v38, 0
    v_mov_b32 v39, 0
    v_cndmask_b32 v11, 0, v209, vcc
L_consts_done:
    s_add_u32 m0, s57, 8192
    s_nop 0
    buffer_load_dwordx4 v192, s[36:39], 0 offen sc1 lds
    s_add_u32 m0, s57, 9216
    s_nop 0
    buffer_load_dwordx4 v194, s[36:39], 0 offen sc1 lds
    s_cmp_eq_u32 s41, 1
    s_cselect_b64 vcc, -1, 0
    s_waitcnt vmcnt(2)
    s_barrier
    s_cbranch_vccz L_c0
    s_setprio 1
L_c0:
    ds_read_b128 v[144:147], v216 offset:0
    ds_read_b128 v[148:151], v217 offset:0
    ds_read_b128 v[152:155], v218 offset:0
    ds_read_b128 v[156:159], v219 offset:0
    ds_read_b128 v[160:163], v241 offset:0
    s_waitcnt lgkmcnt(4)
    v_mfma_f32_32x32x16_bf16 v[96:111], v[144:147], v[4:7], 0
    s_waitcnt lgkmcnt(3)
    v_mfma_f32_32x32x16_bf16 v[96:111], v[148:151], v[8:11], v[96:111]
    s_add_u32 m0, s57, 16384
    s_nop 0
    buffer_load_dwordx4 v196, s[36:39], 0 offen sc1 lds
    s_add_u32 m0, s57, 17408
    s_nop 0
    buffer_load_dwordx4 v198, s[36:39], 0 offen sc1 lds
    s_waitcnt lgkmcnt(2)
    v_mfma_f32_32x32x16_bf16 v[96:111], v[152:155], v[16:19], v[96:111]
    s_waitcnt lgkmcnt(1)
    v_mfma_f32_32x32x16_bf16 v[96:111], v[156:159], v[20:23], v[96:111]
    ds_read_b64_tr_b16 v[164:165], v220 offset:0
    ds_read_b64_tr_b16 v[166:167], v221 offset:0
    ds_read_b64_tr_b16 v[168:169], v220 offset:1024
    ds_read_b64_tr_b16 v[170:171], v221 offset:1024
    s_waitcnt lgkmcnt(4)
    v_mfma_f32_32x32x16_bf16 v[96:111], v[160:163], v[12:15], v[96:111]
    ds_read_b128 v[184:187], v242 offset:768
    s_setprio 0
    s_nop 7
    s_cmp_le_u32 s54, 1
    s_cbranch_scc1 L_exit0s
    s_waitcnt lgkmcnt(0)
    s_cbranch_vccnz L_nba0
    s_waitcnt vmcnt(2)
    s_barrier
L_nba0:
    v_exp_f32 v128, v96
    v_exp_f32 v129, v97
    v_exp_f32 v130, v98
    v_exp_f32 v131, v99
    v_exp_f32 v132, v100
    v_exp_f32 v133, v101
    v_exp_f32 v134, v102
    v_exp_f32 v135, v103
    v_exp_f32 v136, v104
    v_exp_f32 v137, v105
    v_exp_f32 v138, v106
    v_exp_f32 v139, v107
    v_exp_f32 v140, v108
    v_exp_f32 v141, v109
    v_exp_f32 v142, v110
    v_exp_f32 v143, v111
    v_add_f32 v128, 1.0, v128
    v_add_f32 v129, 1.0, v129
    v_add_f32 v130, 1.0, v130
    v_add_f32 v131, 1.0, v131
    v_add_f32 v132, 1.0, v132
    v_add_f32 v133, 1.0, v133
    v_add_f32 v134, 1.0, v134
    v_add_f32 v135, 1.0, v135
    v_add_f32 v136, 1.0, v136
    v_add_f32 v137, 1.0, v137
    v_add_f32 v138, 1.0, v138
    v_add_f32 v139, 1.0, v139
    v_add_f32 v140, 1.0, v140
    v_add_f32 v141, 1.0, v141
    v_add_f32 v142, 1.0, v142
    v_add_f32 v143, 1.0, v143
    v_rcp_f32 v128, v128
    v_rcp_f32 v129, v129
    v_rcp_f32 v130, v130
    v_rcp_f32 v131, v131
    v_rcp_f32 v132, v132
    v_rcp_f32 v133, v133
    v_rcp_f32 v134, v134
    v_rcp_f32 v135, v135
    v_rcp_f32 v136, v136
    v_rcp_f32 v137, v137
    v_rcp_f32 v138, v138
    v_rcp_f32 v139, v139
    v_rcp_f32 v140, v140
    v_rcp_f32 v141, v141
    v_rcp_f32 v142, v142
    v_rcp_f32 v143, v143
    v_pk_mul_f32 v[128:129], v[128:129], v[96:97]
    v_pk_mul_f32 v[130:131], v[130:131], v[98:99]
    v_pk_mul_f32 v[132:133], v[132:133], v[100:101]
    v_pk_mul_f32 v[134:135], v[134:135], v[102:103]
    v_pk_mul_f32 v[136:137], v[136:137], v[104:105]
    v_pk_mul_f32 v[138:139], v[138:139], v[106:107]
    v_pk_mul_f32 v[140:141], v[140:141], v[108:109]
    v_pk_mul_f32 v[142:143], v[142:143], v[110:111]
    v_cvt_pk_bf16_f32 v172, v128, v129
    v_cvt_pk_bf16_f32 v173, v130, v131
    v_cvt_pk_bf16_f32 v174, v132, v133
    v_cvt_pk_bf16_f32 v175, v134, v135
    v_cvt_pk_bf16_f32 v176, v136, v137
    v_cvt_pk_bf16_f32 v177, v138, v139
    v_mfma_f32_32x32x16_bf16 v[24:39], v[172:175], v[164:167], v[24:39]
    v_cvt_pk_bf16_f32 v178, v140, v141
    v_cvt_pk_bf16_f32 v179, v142, v143
    v_lshl_or_b32 v184, v184, 8, v222
    v_lshl_or_b32 v186, v186, 8, v223
    v_mfma_f32_32x32x16_bf16 v[24:39], v[176:179], v[168:171], v[24:39]
    s_cbranch_vccz L_nbb0
    s_waitcnt vmcnt(2)
    s_barrier
L_nbb0:
    ds_read_b128 v[144:147], v216 offset:8192
    ds_read_b128 v[148:151], v217 offset:8192
    ds_read_b128 v[152:155], v218 offset:2048
    ds_read_b128 v[156:159], v219 offset:2048
    ds_read_b128 v[160:163], v241 offset:1024
    s_add_u32 m0, s57, 24576
    s_nop 0
    buffer_load_dwordx4 v184, s[36:39], 0 offen sc1 lds
    s_waitcnt lgkmcnt(4)
    v_mfma_f32_32x32x16_bf16 v[112:127], v[144:147], v[4:7], 0
    s_add_u32 m0, s57, 25600
    s_nop 0
    buffer_load_dwordx4 v186, s[36:39], 0 offen sc1 lds
    s_waitcnt lgkmcnt(3)
    v_mfma_f32_32x32x16_bf16 v[112:127], v[148:151], v[8:11], v[112:127]
    buffer_load_dwordx4 v[64:67], v245, s[32:35], s67 offen offset:0 sc1
    s_waitcnt lgkmcnt(2)
    v_mfma_f32_32x32x16_bf16 v[112:127], v[152:155], v[16:19], v[112:127]
    s_waitcnt lgkmcnt(1)
    v_mfma_f32_32x32x16_bf16 v[112:127], v[156:159], v[20:23], v[112:127]
    ds_read_b64_tr_b16 v[164:165], v220 offset:2048
    ds_read_b64_tr_b16 v[166:167], v221 offset:2048
    ds_read_b64_tr_b16 v[168:169], v220 offset:3072
    ds_read_b64_tr_b16 v[170:171], v221 offset:3072
    s_waitcnt lgkmcnt(4)
    v_mfma_f32_32x32x16_bf16 v[112:127], v[160:163], v[12:15], v[112:127]
    ds_read_b128 v[180:183], v242 offset:1024
    s_nop 7
    s_cmp_le_u32 s54, 2
    s_cbranch_scc1 L_exit1s
    s_waitcnt lgkmcnt(0)
    s_cbranch_vccnz L_nba1
    s_waitcnt vmcnt(3)
    s_barrier
L_nba1:
    v_exp_f32 v128, v112
    v_exp_f32 v129, v113
    v_exp_f32 v130, v114
    v_exp_f32 v131, v115
    v_exp_f32 v132, v116
    v_exp_f32 v133, v117
    v_exp_f32 v134, v118
    v_exp_f32 v135, v119
    v_exp_f32 v136, v120
    v_exp_f32 v137, v121
    v_exp_f32 v138, v122
    v_exp_f32 v139, v123
    v_exp_f32 v140, v124
    v_exp_f32 v141, v125
    v_exp_f32 v142, v126
    v_exp_f32 v143, v127
    v_add_f32 v128, 1.0, v128
    v_add_f32 v129, 1.0, v129
    v_add_f32 v130, 1.0, v130
    v_add_f32 v131, 1.0, v131
    v_add_f32 v132, 1.0, v132
    v_add_f32 v133, 1.0, v133
    v_add_f32 v134, 1.0, v134
    v_add_f32 v135, 1.0, v135
    v_add_f32 v136, 1.0, v136
    v_add_f32 v137, 1.0, v137
    v_add_f32 v138, 1.0, v138
    v_add_f32 v139, 1.0, v139
    v_add_f32 v140, 1.0, v140
    v_add_f32 v141, 1.0, v141
    v_add_f32 v142, 1.0, v142
    v_add_f32 v143, 1.0, v143
    v_rcp_f32 v128, v128
    v_rcp_f32 v129, v129
    v_rcp_f32 v130, v130
    v_rcp_f32 v131, v131
    v_rcp_f32 v132, v132
    v_rcp_f32 v133, v133
    v_rcp_f32 v134, v134
    v_rcp_f32 v135, v135
    v_rcp_f32 v136, v136
    v_rcp_f32 v137, v137
    v_rcp_f32 v138, v138
    v_rcp_f32 v139, v139
    v_rcp_f32 v140, v140
    v_rcp_f32 v141, v141
    v_rcp_f32 v142, v142
    v_rcp_f32 v143, v143
    v_pk_mul_f32 v[128:129], v[128:129], v[112:113]
    v_pk_mul_f32 v[130:131], v[130:131], v[114:115]
    v_pk_mul_f32 v[132:133], v[132:133], v[116:117]
    v_pk_mul_f32 v[134:135], v[134:135], v[118:119]
    v_pk_mul_f32 v[136:137], v[136:137], v[120:121]
    v_pk_mul_f32 v[138:139], v[138:139], v[122:123]
    v_pk_mul_f32 v[140:141], v[140:141], v[124:125]
    v_pk_mul_f32 v[142:143], v[142:143], v[126:127]
    v_cvt_pk_bf16_f32 v172, v128, v129
    v_cvt_pk_bf16_f32 v173, v130, v131
    v_cvt_pk_bf16_f32 v174, v132, v133
    v_cvt_pk_bf16_f32 v175, v134, v135
    v_cvt_pk_bf16_f32 v176, v136, v137
    v_cvt_pk_bf16_f32 v177, v138, v139
    v_mfma_f32_32x32x16_bf16 v[24:39], v[172:175], v[164:167], v[24:39]
    v_cvt_pk_bf16_f32 v178, v140, v141
    v_cvt_pk_bf16_f32 v179, v142, v143
    v_lshl_or_b32 v180, v180, 8, v222
    v_lshl_or_b32 v182, v182, 8, v223
    v_cndmask_b32 v181, v181, v183, s[78:79]
    v_lshl_or_b32 v181, v181, 5, v243
    v_mfma_f32_32x32x16_bf16 v[24:39], v[176:179], v[168:171], v[24:39]
    s_cbranch_vccz L_nbb1
    s_waitcnt vmcnt(3)
    s_barrier
L_nbb1:
    ds_read_b128 v[144:147], v216 offset:16384
    ds_read_b128 v[148:151], v217 offset:16384
    ds_read_b128 v[152:155], v218 offset:4096
    ds_read_b128 v[156:159], v219 offset:4096
    ds_read_b128 v[160:163], v241 offset:2048
    s_add_u32 m0, s66, 4096
    s_mov_b64 exec, s[76:77]
    buffer_load_dwordx4 v181, s[8:11], 0 offen lds
    s_mov_b64 exec, -1
    s_waitcnt lgkmcnt(4)
    v_mfma_f32_32x32x16_bf16 v[96:111], v[144:147], v[4:7], 0
    s_add_u32 m0, s57, 0
    s_nop 0
    buffer_load_dwordx4 v180, s[36:39], 0 offen sc1 lds
    s_waitcnt lgkmcnt(3)
    v_mfma_f32_32x32x16_bf16 v[96:111], v[148:151], v[8:11], v[96:111]
    s_add_u32 m0, s57, 1024
    s_nop 0
    buffer_load_dwordx4 v182, s[36:39], 0 offen sc1 lds
    s_waitcnt lgkmcnt(2)
    v_mfma_f32_32x32x16_bf16 v[96:111], v[152:155], v[16:19], v[96:111]
    buffer_load_dwordx4 v[68:71], v245, s[32:35], s67 offen offset:1024 sc1
    s_waitcnt lgkmcnt(1)
    v_mfma_f32_32x32x16_bf16 v[96:111], v[156:159], v[20:23], v[96:111]
    ds_read_b64_tr_b16 v[164:165], v220 offset:4096
    ds_read_b64_tr_b16 v[166:167], v221 offset:4096
    ds_read_b64_tr_b16 v[168:169], v220 offset:5120
    ds_read_b64_tr_b16 v[170:171], v221 offset:5120
    s_waitcnt lgkmcnt(4)
    v_mfma_f32_32x32x16_bf16 v[96:111], v[160:163], v[12:15], v[96:111]
    ds_read_b128 v[184:187], v242 offset:1280
    s_nop 7
    s_cmp_le_u32 s54, 3
    s_cbranch_scc1 L_exit0s
    s_waitcnt lgkmcnt(0)
    s_cbranch_vccnz L_nba2
    s_waitcnt vmcnt(5)
    s_barrier
L_nba2:
    v_exp_f32 v128, v96
    v_exp_f32 v129, v97
    v_exp_f32 v130, v98
    v_exp_f32 v131, v99
    v_exp_f32 v132, v100
    v_exp_f32 v133, v101
    v_exp_f32 v134, v102
    v_exp_f32 v135, v103
    v_exp_f32 v136, v104
    v_exp_f32 v137, v105
    v_exp_f32 v138, v106
    v_exp_f32 v139, v107
    v_exp_f32 v140, v108
    v_exp_f32 v141, v109
    v_exp_f32 v142, v110
    v_exp_f32 v143, v111
    v_add_f32 v128, 1.0, v128
    v_add_f32 v129, 1.0, v129
    v_add_f32 v130, 1.0, v130
    v_add_f32 v131, 1.0, v131
    v_add_f32 v132, 1.0, v132
    v_add_f32 v133, 1.0, v133
    v_add_f32 v134, 1.0, v134
    v_add_f32 v135, 1.0, v135
    v_add_f32 v136, 1.0, v136
    v_add_f32 v137, 1.0, v137
    v_add_f32 v138, 1.0, v138
    v_add_f32 v139, 1.0, v139
    v_add_f32 v140, 1.0, v140
    v_add_f32 v141, 1.0, v141
    v_add_f32 v142, 1.0, v142
    v_add_f32 v143, 1.0, v143
    v_rcp_f32 v128, v128
    v_rcp_f32 v129, v129
    v_rcp_f32 v130, v130
    v_rcp_f32 v131, v131
    v_rcp_f32 v132, v132
    v_rcp_f32 v133, v133
    v_rcp_f32 v134, v134
    v_rcp_f32 v135, v135
    v_rcp_f32 v136, v136
    v_rcp_f32 v137, v137
    v_rcp_f32 v138, v138
    v_rcp_f32 v139, v139
    v_rcp_f32 v140, v140
    v_rcp_f32 v141, v141
    v_rcp_f32 v142, v142
    v_rcp_f32 v143, v143
    v_pk_mul_f32 v[128:129], v[128:129], v[96:97]
    v_pk_mul_f32 v[130:131], v[130:131], v[98:99]
    v_pk_mul_f32 v[132:133], v[132:133], v[100:101]
    v_pk_mul_f32 v[134:135], v[134:135], v[102:103]
    v_pk_mul_f32 v[136:137], v[136:137], v[104:105]
    v_pk_mul_f32 v[138:139], v[138:139], v[106:107]
    v_pk_mul_f32 v[140:141], v[140:141], v[108:109]
    v_pk_mul_f32 v[142:143], v[142:143], v[110:111]
    v_cvt_pk_bf16_f32 v172, v128, v129
    v_cvt_pk_bf16_f32 v173, v130, v131
    v_cvt_pk_bf16_f32 v174, v132, v133
    v_cvt_pk_bf16_f32 v175, v134, v135
    v_cvt_pk_bf16_f32 v176, v136, v137
    v_cvt_pk_bf16_f32 v177, v138, v139
    v_mfma_f32_32x32x16_bf16 v[24:39], v[172:175], v[164:167], v[24:39]
    v_cvt_pk_bf16_f32 v178, v140, v141
    v_cvt_pk_bf16_f32 v179, v142, v143
    v_lshl_or_b32 v184, v184, 8, v222
    v_lshl_or_b32 v186, v186, 8, v223
    v_cndmask_b32 v185, v185, v187, s[78:79]
    v_lshl_or_b32 v185, v185, 5, v243
    v_mfma_f32_32x32x16_bf16 v[24:39], v[176:179], v[168:171], v[24:39]
    s_cbranch_vccz L_nbb2
    s_waitcnt vmcnt(5)
    s_barrier
L_nbb2:
    ds_read_b128 v[144:147], v216 offset:24576
    ds_read_b128 v[148:151], v217 offset:24576
    ds_read_b128 v[152:155], v218 offset:6144
    ds_read_b128 v[156:159], v219 offset:6144
    ds_read_b128 v[160:163], v241 offset:3072
    s_add_u32 m0, s66, 5120
    s_mov_b64 exec, s[76:77]
    buffer_load_dwordx4 v185, s[8:11], 0 offen lds
    s_mov_b64 exec, -1
    s_waitcnt lgkmcnt(4)
    v_mfma_f32_32x32x16_bf16 v[112:127], v[144:147], v[4:7], 0
    s_add_u32 m0, s57, 8192
    s_nop 0
    buffer_load_dwordx4 v184, s[36:39], 0 offen sc1 lds
    s_waitcnt lgkmcnt(3)
    v_mfma_f32_32x32x16_bf16 v[112:127], v[148:151], v[8:11], v[112:127]
    s_add_u32 m0, s57, 9216
    s_nop 0
    buffer_load_dwordx4 v186, s[36:39], 0 offen sc1 lds
    s_waitcnt lgkmcnt(2)
    v_mfma_f32_32x32x16_bf16 v[112:127], v[152:155], v[16:19], v[112:127]
    buffer_load_dwordx4 v[72:75], v245, s[32:35], s67 offen offset:2048 sc1
    s_waitcnt lgkmcnt(1)
    v_mfma_f32_32x32x16_bf16 v[112:127], v[156:159], v[20:23], v[112:127]
    ds_read_b64_tr_b16 v[164:165], v220 offset:6144
    ds_read_b64_tr_b16 v[166:167], v221 offset:6144
    ds_read_b64_tr_b16 v[168:169], v220 offset:7168
    ds_read_b64_tr_b16 v[170:171], v221 offset:7168
    s_waitcnt lgkmcnt(4)
    v_mfma_f32_32x32x16_bf16 v[112:127], v[160:163], v[12:15], v[112:127]
    ds_read_b128 v[180:183], v242 offset:1536
    ds_read_b128 v[184:187], v242 offset:1792
    s_nop 7
    s_cmp_le_u32 s54, 4
    s_cbranch_scc1 L_exit1s
    s_waitcnt lgkmcnt(0)
    s_cbranch_vccnz L_nba3
    s_waitcnt vmcnt(5)
    s_barrier
L_nba3:
    v_exp_f32 v128, v112
    v_exp_f32 v129, v113
    v_exp_f32 v130, v114
    v_exp_f32 v131, v115
    v_exp_f32 v132, v116
    v_exp_f32 v133, v117
    v_exp_f32 v134, v118
    v_exp_f32 v135, v119
    v_exp_f32 v136, v120
    v_exp_f32 v137, v121
    v_exp_f32 v138, v122
    v_exp_f32 v139, v123
    v_exp_f32 v140, v124
    v_exp_f32 v141, v125
    v_exp_f32 v142, v126
    v_exp_f32 v143, v127
    v_add_f32 v128, 1.0, v128
    v_add_f32 v129, 1.0, v129
    v_add_f32 v130, 1.0, v130
    v_add_f32 v131, 1.0, v131
    v_add_f32 v132, 1.0, v132
    v_add_f32 v133, 1.0, v133
    v_add_f32 v134, 1.0, v134
    v_add_f32 v135, 1.0, v135
    v_add_f32 v136, 1.0, v136
    v_add_f32 v137, 1.0, v137
    v_add_f32 v138, 1.0, v138
    v_add_f32 v139, 1.0, v139
    v_add_f32 v140, 1.0, v140
    v_add_f32 v141, 1.0, v141
    v_add_f32 v142, 1.0, v142
    v_add_f32 v143, 1.0, v143
    v_rcp_f32 v128, v128
    v_rcp_f32 v129, v129
    v_rcp_f32 v130, v130
    v_rcp_f32 v131, v131
    v_rcp_f32 v132, v132
    v_rcp_f32 v133, v133
    v_rcp_f32 v134, v134
    v_rcp_f32 v135, v135
    v_rcp_f32 v136, v136
    v_rcp_f32 v137, v137
    v_rcp_f32 v138, v138
    v_rcp_f32 v139, v139
    v_rcp_f32 v140, v140
    v_rcp_f32 v141, v141
    v_rcp_f32 v142, v142
    v_rcp_f32 v143, v143
    v_pk_mul_f32 v[128:129], v[128:129], v[112:113]
    v_pk_mul_f32 v[130:131], v[130:131], v[114:115]
    v_pk_mul_f32 v[132:133], v[132:133], v[116:117]
    v_pk_mul_f32 v[134:135], v[134:135], v[118:119]
    v_pk_mul_f32 v[136:137], v[136:137], v[120:121]
    v_pk_mul_f32 v[138:139], v[138:139], v[122:123]
    v_pk_mul_f32 v[140:141], v[140:141], v[124:125]
    v_pk_mul_f32 v[142:143], v[142:143], v[126:127]
    v_cvt_pk_bf16_f32 v172, v128, v129
    v_cvt_pk_bf16_f32 v173, v130, v131
    v_cvt_pk_bf16_f32 v174, v132, v133
    v_cvt_pk_bf16_f32 v175, v134, v135
    v_cvt_pk_bf16_f32 v176, v136, v137
    v_cvt_pk_bf16_f32 v177, v138, v139
    v_mfma_f32_32x32x16_bf16 v[24:39], v[172:175], v[164:167], v[24:39]
    v_cvt_pk_bf16_f32 v178, v140, v141
    v_cvt_pk_bf16_f32 v179, v142, v143
    v_lshl_or_b32 v180, v180, 8, v222
    v_lshl_or_b32 v182, v182, 8, v223
    v_cndmask_b32 v181, v181, v183, s[78:79]
    v_lshl_or_b32 v181, v181, 5, v243
    v_lshl_or_b32 v184, v184, 8, v222
    v_lshl_or_b32 v186, v186, 8, v223
    v_cndmask_b32 v185, v185, v187, s[78:79]
    v_lshl_or_b32 v185, v185, 5, v243
    v_xor_b32 v208, 0, v232
    v_xor_b32 v209, 0, v233
    v_xor_b32 v210, 0, v234
    v_mfma_f32_32x32x16_bf16 v[24:39], v[176:179], v[168:171], v[24:39]
    s_cbranch_vccz L_nbb3
    s_waitcnt vmcnt(5)
    s_barrier
L_nbb3:
    ds_read_b128 v[144:147], v216 offset:0
    ds_read_b128 v[148:151], v217 offset:0
    ds_read_b128 v[152:155], v218 offset:8192
    ds_read_b128 v[156:159], v219 offset:8192
    ds_read_b128 v[160:163], v241 offset:4096
    s_add_u32 m0, s66, 6144
    s_mov_b64 exec, s[76:77]
    buffer_load_dwordx4 v181, s[8:11], 0 offen lds
    s_mov_b64 exec, -1
    s_waitcnt lgkmcnt(4)
    v_mfma_f32_32x32x16_bf16 v[96:111], v[144:147], v[4:7], 0
    s_add_u32 m0, s57, 16384
    s_nop 0
    buffer_load_dwordx4 v180, s[36:39], 0 offen sc1 lds
    s_waitcnt lgkmcnt(3)
    v_mfma_f32_32x32x16_bf16 v[96:111], v[148:151], v[8:11], v[96:111]
    s_add_u32 m0, s57, 17408
    s_nop 0
    buffer_load_dwordx4 v182, s[36:39], 0 offen sc1 lds
    s_waitcnt lgkmcnt(2)
    v_mfma_f32_32x32x16_bf16 v[96:111], v[152:155], v[16:19], v[96:111]
    s_add_u32 m0, s66, 7168
    s_mov_b64 exec, s[76:77]
    buffer_load_dwordx4 v185, s[8:11], 0 offen lds
    s_mov_b64 exec, -1
    s_waitcnt lgkmcnt(1)
    v_mfma_f32_32x32x16_bf16 v[96:111], v[156:159], v[20:23], v[96:111]
    ds_read_b64_tr_b16 v[164:165], v220 offset:8192
    ds_read_b64_tr_b16 v[166:167], v221 offset:8192
    ds_read_b64_tr_b16 v[168:169], v220 offset:9216
    ds_read_b64_tr_b16 v[170:171], v221 offset:9216
    s_waitcnt lgkmcnt(4)
    v_mfma_f32_32x32x16_bf16 v[96:111], v[160:163], v[12:15], v[96:111]
    s_add_u32 m0, s57, 24576
    s_nop 0
    buffer_load_dwordx4 v184, s[36:39], 0 offen sc1 lds
    ds_read_b128 v[52:55], v208
    ds_read_b128 v[56:59], v209
    ds_read_b128 v[60:63], v210
    s_add_u32 m0, s57, 25600
    s_nop 0
    buffer_load_dwordx4 v186, s[36:39], 0 offen sc1 lds
    buffer_load_dwordx4 v[76:79], v245, s[32:35], s67 offen offset:3072 sc1
    ds_read_b128 v[180:183], v242 offset:2048
    s_nop 7
    s_cmp_le_u32 s54, 5
    s_cbranch_scc1 L_exit0s
    s_waitcnt lgkmcnt(0)
    s_cbranch_vccnz L_nba4
    s_waitcnt vmcnt(8)
    s_barrier
L_nba4:
    v_exp_f32 v128, v96
    v_mfma_f32_16x16x32_bf16 v[40:43], v[64:67], v[52:55], 0
    v_exp_f32 v129, v97
    v_mfma_f32_16x16x32_bf16 v[44:47], v[64:67], v[56:59], 0
    v_exp_f32 v130, v98
    v_mfma_f32_16x16x32_bf16 v[48:51], v[64:67], v[60:63], 0
    v_exp_f32 v131, v99
    v_exp_f32 v132, v100
    v_exp_f32 v133, v101
    v_exp_f32 v134, v102
    v_exp_f32 v135, v103
    v_exp_f32 v136, v104
    v_exp_f32 v137, v105
    v_exp_f32 v138, v106
    v_exp_f32 v139, v107
    v_exp_f32 v140, v108
    v_exp_f32 v141, v109
    v_exp_f32 v142, v110
    v_exp_f32 v143, v111
    v_add_f32 v128, 1.0, v128
    v_add_f32 v129, 1.0, v129
    v_add_f32 v130, 1.0, v130
    v_add_f32 v131, 1.0, v131
    v_add_f32 v132, 1.0, v132
    v_add_f32 v133, 1.0, v133
    v_add_f32 v134, 1.0, v134
    v_add_f32 v135, 1.0, v135
    v_add_f32 v136, 1.0, v136
    v_add_f32 v137, 1.0, v137
    v_add_f32 v138, 1.0, v138
    v_add_f32 v139, 1.0, v139
    v_add_f32 v140, 1.0, v140
    v_add_f32 v141, 1.0, v141
    v_add_f32 v142, 1.0, v142
    v_add_f32 v143, 1.0, v143
    v_rcp_f32 v128, v128
    v_rcp_f32 v129, v129
    v_rcp_f32 v130, v130
    v_rcp_f32 v131, v131
    v_rcp_f32 v132, v132
    v_rcp_f32 v133, v133
    v_rcp_f32 v134, v134
    v_rcp_f32 v135, v135
    v_rcp_f32 v136, v136
    v_rcp_f32 v137, v137
    v_rcp_f32 v138, v138
    v_rcp_f32 v139, v139
    v_rcp_f32 v140, v140
    v_rcp_f32 v141, v141
    v_rcp_f32 v142, v142
    v_rcp_f32 v143, v143
    v_pk_mul_f32 v[128:129], v[128:129], v[96:97]
    v_pk_mul_f32 v[130:131], v[130:131], v[98:99]
    v_pk_mul_f32 v[132:133], v[132:133], v[100:101]
    v_pk_mul_f32 v[134:135], v[134:135], v[102:103]
    v_pk_mul_f32 v[136:137], v[136:137], v[104:105]
    v_pk_mul_f32 v[138:139], v[138:139], v[106:107]
    v_pk_mul_f32 v[140:141], v[140:141], v[108:109]
    v_pk_mul_f32 v[142:143], v[142:143], v[110:111]
    v_cvt_pk_bf16_f32 v172, v128, v129
    v_cvt_pk_bf16_f32 v173, v130, v131
    v_cvt_pk_bf16_f32 v174, v132, v133
    v_cvt_pk_bf16_f32 v175, v134, v135
    v_cvt_pk_bf16_f32 v176, v136, v137
    v_cvt_pk_bf16_f32 v177, v138, v139
    v_mfma_f32_32x32x16_bf16 v[24:39], v[172:175], v[164:167], v[24:39]
    v_cvt_pk_bf16_f32 v178, v140, v141
    v_cvt_pk_bf16_f32 v179, v142, v143
    v_lshl_or_b32 v180, v180, 8, v222
    v_lshl_or_b32 v182, v182, 8, v223
    v_cndmask_b32 v181, v181, v183, s[78:79]
    v_lshl_or_b32 v181, v181, 5, v243
    v_xor_b32 v208, 64, v232
    v_xor_b32 v209, 64, v233
    v_xor_b32 v210, 64, v234
    v_mfma_f32_32x32x16_bf16 v[24:39], v[176:179], v[168:171], v[24:39]
    s_cbranch_vccz L_nbb4
    s_waitcnt vmcnt(8)
    s_barrier
L_nbb4:
    ds_read_b128 v[144:147], v216 offset:8192
    ds_read_b128 v[148:151], v217 offset:8192
    ds_read_b128 v[152:155], v218 offset:10240
    ds_read_b128 v[156:159], v219 offset:10240
    ds_read_b128 v[160:163], v241 offset:5120
    s_add_u32 m0, s66, 8192
    s_mov_b64 exec, s[76:77]
    buffer_load_dwordx4 v181, s[8:11], 0 offen lds
    s_mov_b64 exec, -1
    s_waitcnt lgkmcnt(4)
    v_mfma_f32_32x32x16_bf16 v[112:127], v[144:147], v[4:7], 0
    s_add_u32 m0, s57, 0
    s_nop 0
    buffer_load_dwordx4 v180, s[36:39], 0 offen sc1 lds
    s_waitcnt lgkmcnt(3)
    v_mfma_f32_32x32x16_bf16 v[112:127], v[148:151], v[8:11], v[112:127]
    s_add_u32 m0, s57, 1024
    s_nop 0
    buffer_load_dwordx4 v182, s[36:39], 0 offen sc1 lds
    s_waitcnt lgkmcnt(2)
    v_mfma_f32_32x32x16_bf16 v[112:127], v[152:155], v[16:19], v[112:127]
    buffer_load_dwordx4 v[80:83], v246, s[32:35], s67 offen offset:0 sc1
    s_waitcnt lgkmcnt(1)
    v_mfma_f32_32x32x16_bf16 v[112:127], v[156:159], v[20:23], v[112:127]
    ds_read_b64_tr_b16 v[164:165], v220 offset:10240
    ds_read_b64_tr_b16 v[166:167], v221 offset:10240
    ds_read_b64_tr_b16 v[168:169], v220 offset:11264
    ds_read_b64_tr_b16 v[170:171], v221 offset:11264
    s_waitcnt lgkmcnt(4)
    v_mfma_f32_32x32x16_bf16 v[112:127], v[160:163], v[12:15], v[112:127]
    ds_read_b128 v[52:55], v208
    ds_read_b128 v[56:59], v209
    ds_read_b128 v[60:63], v210
    ds_read_b128 v[184:187], v242 offset:2304
    s_nop 7
    s_cmp_le_u32 s54, 6
    s_cbranch_scc1 L_exit1s
    s_waitcnt lgkmcnt(0)
    s_cbranch_vccnz L_nba5
    s_waitcnt vmcnt(5)
    s_barrier
L_nba5:
    v_exp_f32 v128, v112
    v_mfma_f32_16x16x32_bf16 v[40:43], v[68:71], v[52:55], v[40:43]
    v_exp_f32 v129, v113
    v_mfma_f32_16x16x32_bf16 v[44:47], v[68:71], v[56:59], v[44:47]
    v_exp_f32 v130, v114
    v_mfma_f32_16x16x32_bf16 v[48:51], v[68:71], v[60:63], v[48:51]
    v_exp_f32 v131, v115
    v_exp_f32 v132, v116
    v_exp_f32 v133, v117
    v_exp_f32 v134, v118
    v_exp_f32 v135, v119
    v_exp_f32 v136, v120
    v_exp_f32 v137, v121
    v_exp_f32 v138, v122
    v_exp_f32 v139, v123
    v_exp_f32 v140, v124
    v_exp_f32 v141, v125
    v_exp_f32 v142, v126
    v_exp_f32 v143, v127
    v_add_f32 v128, 1.0, v128
    v_add_f32 v129, 1.0, v129
    v_add_f32 v130, 1.0, v130
    v_add_f32 v131, 1.0, v131
    v_add_f32 v132, 1.0, v132
    v_add_f32 v133, 1.0, v133
    v_add_f32 v134, 1.0, v134
    v_add_f32 v135, 1.0, v135
    v_add_f32 v136, 1.0, v136
    v_add_f32 v137, 1.0, v137
    v_add_f32 v138, 1.0, v138
    v_add_f32 v139, 1.0, v139
    v_add_f32 v140, 1.0, v140
    v_add_f32 v141, 1.0, v141
    v_add_f32 v142, 1.0, v142
    v_add_f32 v143, 1.0, v143
    v_rcp_f32 v128, v128
    v_rcp_f32 v129, v129
    v_rcp_f32 v130, v130
    v_rcp_f32 v131, v131
    v_rcp_f32 v132, v132
    v_rcp_f32 v133, v133
    v_rcp_f32 v134, v134
    v_rcp_f32 v135, v135
    v_rcp_f32 v136, v136
    v_rcp_f32 v137, v137
    v_rcp_f32 v138, v138
    v_rcp_f32 v139, v139
    v_rcp_f32 v140, v140
    v_rcp_f32 v141, v141
    v_rcp_f32 v142, v142
    v_rcp_f32 v143, v143
    v_pk_mul_f32 v[128:129], v[128:129], v[112:113]
    v_pk_mul_f32 v[130:131], v[130:131], v[114:115]
    v_pk_mul_f32 v[132:133], v[132:133], v[116:117]
    v_pk_mul_f32 v[134:135], v[134:135], v[118:119]
    v_pk_mul_f32 v[136:137], v[136:137], v[120:121]
    v_pk_mul_f32 v[138:139], v[138:139], v[122:123]
    v_pk_mul_f32 v[140:141], v[140:141], v[124:125]
    v_pk_mul_f32 v[142:143], v[142:143], v[126:127]
    v_cvt_pk_bf16_f32 v172, v128, v129
    v_cvt_pk_bf16_f32 v173, v130, v131
    v_cvt_pk_bf16_f32 v174, v132, v133
    v_cvt_pk_bf16_f32 v175, v134, v135
    v_cvt_pk_bf16_f32 v176, v136, v137
    v_cvt_pk_bf16_f32 v177, v138, v139
    v_mfma_f32_32x32x16_bf16 v[24:39], v[172:175], v[164:167], v[24:39]
    v_cvt_pk_bf16_f32 v178, v140, v141
    v_cvt_pk_bf16_f32 v179, v142, v143
    v_lshl_or_b32 v184, v184, 8, v222
    v_lshl_or_b32 v186, v186, 8, v223
    v_cndmask_b32 v185, v185, v187, s[78:79]
    v_lshl_or_b32 v185, v185, 5, v243
    v_xor_b32 v208, 128, v232
    v_xor_b32 v209, 128, v233
    v_xor_b32 v210, 128, v234
    v_mfma_f32_32x32x16_bf16 v[24:39], v[176:179], v[168:171], v[24:39]
    s_cbranch_vccz L_nbb5
    s_waitcnt vmcnt(5)
    s_barrier
L_nbb5:
    ds_read_b128 v[144:147], v216 offset:16384
    ds_read_b128 v[148:151], v217 offset:16384
    ds_read_b128 v[152:155], v218 offset:12288
    ds_read_b128 v[156:159], v219 offset:12288
    ds_read_b128 v[160:163], v241 offset:6144
    s_add_u32 m0, s66, 9216
    s_mov_b64 exec, s[76:77]
    buffer_load_dwordx4 v185, s[8:11], 0 offen lds
    s_mov_b64 exec, -1
    s_waitcnt lgkmcnt(4)
    v_mfma_f32_32x32x16_bf16 v[96:111], v[144:147], v[4:7], 0
    ds_read_b128 v[144:147], v216 offset:24576
    s_add_u32 m0, s57, 8192
    s_nop 0
    buffer_load_dwordx4 v184, s[36:39], 0 offen sc1 lds
    s_waitcnt lgkmcnt(4)
    v_mfma_f32_32x32x16_bf16 v[96:111], v[148:151], v[8:11], v[96:111]
    ds_read_b128 v[148:151], v217 offset:24576
    s_add_u32 m0, s57, 9216
    s_nop 0
    buffer_load_dwordx4 v186, s[36:39], 0 offen sc1 lds
    s_waitcnt lgkmcnt(4)
    v_mfma_f32_32x32x16_bf16 v[96:111], v[152:155], v[16:19], v[96:111]
    ds_read_b128 v[152:155], v218 offset:14336
    buffer_load_dwordx4 v[84:87], v246, s[32:35], s67 offen offset:1024 sc1
    s_waitcnt lgkmcnt(4)
    v_mfma_f32_32x32x16_bf16 v[96:111], v[156:159], v[20:23], v[96:111]
    ds_read_b128 v[156:159], v219 offset:14336
    ds_read_b64_tr_b16 v[164:165], v220 offset:12288
    ds_read_b64_tr_b16 v[166:167], v221 offset:12288
    ds_read_b64_tr_b16 v[168:169], v220 offset:13312
    ds_read_b64_tr_b16 v[170:171], v221 offset:13312
    s_waitcnt lgkmcnt(8)
    v_mfma_f32_32x32x16_bf16 v[96:111], v[160:163], v[12:15], v[96:111]
    ds_read_b128 v[160:163], v241 offset:7168
    ds_read_b128 v[52:55], v208
    ds_read_b128 v[56:59], v209
    ds_read_b128 v[60:63], v210
    ds_read_b128 v[180:183], v242 offset:2560
    ds_read_b128 v[184:187], v242 offset:2816
    s_nop 7
    s_cmp_le_u32 s54, 7
    s_cbranch_scc1 L_exit0s
    s_waitcnt lgkmcnt(0)
    s_cbranch_vccnz L_nba6
    s_waitcnt vmcnt(5)
    s_barrier
L_nba6:
    v_mfma_f32_32x32x16_bf16 v[112:127], v[144:147], v[4:7], 0
    v_exp_f32 v128, v96
    v_exp_f32 v129, v97
    v_exp_f32 v130, v98
    v_mfma_f32_32x32x16_bf16 v[112:127], v[148:151], v[8:11], v[112:127]
    v_exp_f32 v131, v99
    v_exp_f32 v132, v100
    v_exp_f32 v133, v101
    v_exp_f32 v134, v102
    v_exp_f32 v135, v103
    v_pk_add_f32 v[128:129], v[128:129], 1.0 op_sel_hi:[1,0]
    v_pk_add_f32 v[130:131], v[130:131], 1.0 op_sel_hi:[1,0]
    v_pk_add_f32 v[132:133], v[132:133], 1.0 op_sel_hi:[1,0]
    v_pk_add_f32 v[134:135], v[134:135], 1.0 op_sel_hi:[1,0]
    v_mfma_f32_32x32x16_bf16 v[112:127], v[152:155], v[16:19], v[112:127]
    v_rcp_f32 v128, v128
    v_rcp_f32 v129, v129
    v_rcp_f32 v130, v130
    v_mfma_f32_32x32x16_bf16 v[112:127], v[156:159], v[20:23], v[112:127]
    v_rcp_f32 v131, v131
    v_rcp_f32 v132, v132
    v_rcp_f32 v133, v133
    v_rcp_f32 v134, v134
    v_rcp_f32 v135, v135
    v_pk_mul_f32 v[128:129], v[128:129], v[96:97]
    v_pk_mul_f32 v[130:131], v[130:131], v[98:99]
    v_pk_mul_f32 v[132:133], v[132:133], v[100:101]
    v_pk_mul_f32 v[134:135], v[134:135], v[102:103]
    v_mfma_f32_32x32x16_bf16 v[112:127], v[160:163], v[12:15], v[112:127]
    v_cvt_pk_bf16_f32 v172, v128, v129
    v_cvt_pk_bf16_f32 v173, v130, v131
    v_cvt_pk_bf16_f32 v174, v132, v133
    v_cvt_pk_bf16_f32 v175, v134, v135
    v_exp_f32 v136, v104
    v_exp_f32 v137, v105
    v_mfma_f32_32x32x16_bf16 v[24:39], v[172:175], v[164:167], v[24:39]
    v_exp_f32 v138, v106
    v_exp_f32 v139, v107
    v_exp_f32 v140, v108
    v_exp_f32 v141, v109
    v_exp_f32 v142, v110
    v_exp_f32 v143, v111
    v_pk_add_f32 v[136:137], v[136:137], 1.0 op_sel_hi:[1,0]
    v_pk_add_f32 v[138:139], v[138:139], 1.0 op_sel_hi:[1,0]
    v_pk_add_f32 v[140:141], v[140:141], 1.0 op_sel_hi:[1,0]
    v_pk_add_f32 v[142:143], v[142:143], 1.0 op_sel_hi:[1,0]
    v_mfma_f32_16x16x32_bf16 v[40:43], v[72:75], v[52:55], v[40:43]
    v_rcp_f32 v136, v136
    v_mfma_f32_16x16x32_bf16 v[44:47], v[72:75], v[56:59], v[44:47]
    v_rcp_f32 v137, v137
    v_mfma_f32_16x16x32_bf16 v[48:51], v[72:75], v[60:63], v[48:51]
    v_rcp_f32 v138, v138
    v_rcp_f32 v139, v139
    v_rcp_f32 v140, v140
    v_rcp_f32 v141, v141
    v_rcp_f32 v142, v142
    v_rcp_f32 v143, v143
    v_pk_mul_f32 v[136:137], v[136:137], v[104:105]
    v_pk_mul_f32 v[138:139], v[138:139], v[106:107]
    v_pk_mul_f32 v[140:141], v[140:141], v[108:109]
    v_pk_mul_f32 v[142:143], v[142:143], v[110:111]
    v_cvt_pk_bf16_f32 v176, v136, v137
    v_cvt_pk_bf16_f32 v177, v138, v139
    v_cvt_pk_bf16_f32 v178, v140, v141
    v_cvt_pk_bf16_f32 v179, v142, v143
    v_lshl_or_b32 v180, v180, 8, v222
    v_lshl_or_b32 v182, v182, 8, v223
    v_cndmask_b32 v181, v181, v183, s[78:79]
    v_lshl_or_b32 v181, v181, 5, v243
    v_lshl_or_b32 v184, v184, 8, v222
    v_lshl_or_b32 v186, v186, 8, v223
    v_cndmask_b32 v185, v185, v187, s[78:79]
    v_lshl_or_b32 v185, v185, 5, v243
    v_xor_b32 v208, 192, v232
    v_xor_b32 v209, 192, v233
    v_xor_b32 v210, 192, v234
    v_mfma_f32_32x32x16_bf16 v[24:39], v[176:179], v[168:171], v[24:39]
    s_cbranch_vccz L_nbb6
    s_waitcnt vmcnt(5)
    s_barrier
L_nbb6:
    ds_read_b128 v[144:147], v216 offset:0
    ds_read_b128 v[148:151], v217 offset:0
    ds_read_b128 v[152:155], v218 offset:16384
    ds_read_b128 v[156:159], v219 offset:16384
    ds_read_b128 v[160:163], v241 offset:8192
    ds_read_b64_tr_b16 v[164:165], v220 offset:14336
    ds_read_b64_tr_b16 v[166:167], v221 offset:14336
    ds_read_b64_tr_b16 v[168:169], v220 offset:15360
    ds_read_b64_tr_b16 v[170:171], v221 offset:15360
    ds_read_b128 v[52:55], v208
    ds_read_b128 v[56:59], v209
    ds_read_b128 v[60:63], v210
    s_add_u32 m0, s66, 10240
    s_mov_b64 exec, s[76:77]
    buffer_load_dwordx4 v181, s[8:11], 0 offen lds
    s_mov_b64 exec, -1
    s_add_u32 m0, s57, 16384
    s_nop 0
    buffer_load_dwordx4 v180, s[36:39], 0 offen sc1 lds
    s_add_u32 m0, s57, 17408
    s_nop 0
    buffer_load_dwordx4 v182, s[36:39], 0 offen sc1 lds
    s_add_u32 m0, s66, 11264
    s_mov_b64 exec, s[76:77]
    buffer_load_dwordx4 v185, s[8:11], 0 offen lds
    s_mov_b64 exec, -1
    s_add_u32 m0, s57, 24576
    s_nop 0
    buffer_load_dwordx4 v184, s[36:39], 0 offen sc1 lds
    s_add_u32 m0, s57, 25600
    s_nop 0
    buffer_load_dwordx4 v186, s[36:39], 0 offen sc1 lds
    buffer_load_dwordx4 v[88:91], v246, s[32:35], s67 offen offset:2048 sc1
    ds_read_b128 v[180:183], v242 offset:3072
    s_cmp_le_u32 s54, 8
    s_cbranch_scc1 L_exit1s
    s_waitcnt lgkmcnt(0)
    s_cbranch_vccnz L_nba7
    s_waitcnt vmcnt(8)
    s_barrier
L_nba7:
    v_mfma_f32_32x32x16_bf16 v[96:111], v[144:147], v[4:7], 0
    v_exp_f32 v128, v112
    v_exp_f32 v129, v113
    v_exp_f32 v130, v114
    v_mfma_f32_32x32x16_bf16 v[96:111], v[148:151], v[8:11], v[96:111]
    v_exp_f32 v131, v115
    v_exp_f32 v132, v116
    v_exp_f32 v133, v117
    v_exp_f32 v134, v118
    v_exp_f32 v135, v119
    v_pk_add_f32 v[128:129], v[128:129], 1.0 op_sel_hi:[1,0]
    v_pk_add_f32 v[130:131], v[130:131], 1.0 op_sel_hi:[1,0]
    v_pk_add_f32 v[132:133], v[132:133], 1.0 op_sel_hi:[1,0]
    v_pk_add_f32 v[134:135], v[134:135], 1.0 op_sel_hi:[1,0]
    v_mfma_f32_32x32x16_bf16 v[96:111], v[152:155], v[16:19], v[96:111]
    v_rcp_f32 v128, v128
    v_rcp_f32 v129, v129
    v_rcp_f32 v130, v130
    v_mfma_f32_32x32x16_bf16 v[96:111], v[156:159], v[20:23], v[96:111]
    v_rcp_f32 v131, v131
    v_rcp_f32 v132, v132
    v_rcp_f32 v133, v133
    v_rcp_f32 v134, v134
    v_rcp_f32 v135, v135
    v_pk_mul_f32 v[128:129], v[128:129], v[112:113]
    v_pk_mul_f32 v[130:131], v[130:131], v[114:115]
    v_pk_mul_f32 v[132:133], v[132:133], v[116:117]
    v_pk_mul_f32 v[134:135], v[134:135], v[118:119]
    v_mfma_f32_32x32x16_bf16 v[96:111], v[160:163], v[12:15], v[96:111]
    v_cvt_pk_bf16_f32 v172, v128, v129
    v_cvt_pk_bf16_f32 v173, v130, v131
    v_cvt_pk_bf16_f32 v174, v132, v133
    v_cvt_pk_bf16_f32 v175, v134, v135
    v_exp_f32 v136, v120
    v_exp_f32 v137, v121
    v_mfma_f32_32x32x16_bf16 v[24:39], v[172:175], v[164:167], v[24:39]
    v_exp_f32 v138, v122
    v_exp_f32 v139, v123
    v_exp_f32 v140, v124
    v_exp_f32 v141, v125
    v_exp_f32 v142, v126
    v_exp_f32 v143, v127
    v_pk_add_f32 v[136:137], v[136:137], 1.0 op_sel_hi:[1,0]
    v_pk_add_f32 v[138:139], v[138:139], 1.0 op_sel_hi:[1,0]
    v_pk_add_f32 v[140:141], v[140:141], 1.0 op_sel_hi:[1,0]
    v_pk_add_f32 v[142:143], v[142:143], 1.0 op_sel_hi:[1,0]
    v_mfma_f32_16x16x32_bf16 v[40:43], v[76:79], v[52:55], v[40:43]
    v_rcp_f32 v136, v136
    v_mfma_f32_16x16x32_bf16 v[44:47], v[76:79], v[56:59], v[44:47]
    v_rcp_f32 v137, v137
    v_mfma_f32_16x16x32_bf16 v[48:51], v[76:79], v[60:63], v[48:51]
    v_rcp_f32 v138, v138
    v_rcp_f32 v139, v139
    v_rcp_f32 v140, v140
    v_rcp_f32 v141, v141
    v_rcp_f32 v142, v142
    v_rcp_f32 v143, v143
    v_pk_mul_f32 v[136:137], v[136:137], v[120:121]
    v_pk_mul_f32 v[138:139], v[138:139], v[122:123]
    v_pk_mul_f32 v[140:141], v[140:141], v[124:125]
    v_pk_mul_f32 v[142:143], v[142:143], v[126:127]
    v_pk_mul_f32 v[40:41], v[40:41], s[62:63]
    v_pk_mul_f32 v[42:43], v[42:43], s[62:63]
    v_pk_mul_f32 v[44:45], v[44:45], s[62:63]
    v_pk_mul_f32 v[46:47], v[46:47], s[62:63]
    v_pk_mul_f32 v[48:49], v[48:49], s[62:63]
    v_pk_mul_f32 v[50:51], v[50:51], s[62:63]
    v_cvt_pk_bf16_f32 v176, v136, v137
    v_cvt_pk_bf16_f32 v177, v138, v139
    v_cvt_pk_bf16_f32 v178, v140, v141
    v_cvt_pk_bf16_f32 v179, v142, v143
    v_lshl_or_b32 v180, v180, 8, v222
    v_lshl_or_b32 v182, v182, 8, v223
    v_cndmask_b32 v181, v181, v183, s[78:79]
    v_lshl_or_b32 v181, v181, 5, v243
    v_mfma_f32_32x32x16_bf16 v[24:39], v[176:179], v[168:171], v[24:39]
    s_cbranch_vccz L_nbb7
    s_waitcnt vmcnt(8)
    s_barrier
L_nbb7:
    ds_read_b128 v[144:147], v216 offset:8192
    ds_read_b128 v[148:151], v217 offset:8192
    ds_read_b128 v[152:155], v218 offset:18432
    ds_read_b128 v[156:159], v219 offset:18432
    ds_read_b128 v[160:163], v241 offset:9216
    ds_read_b64_tr_b16 v[164:165], v220 offset:16384
    ds_read_b64_tr_b16 v[166:167], v221 offset:16384
    ds_read_b64_tr_b16 v[168:169], v220 offset:17408
    ds_read_b64_tr_b16 v[170:171], v221 offset:17408
    s_add_u32 m0, s66, 12288
    s_mov_b64 exec, s[76:77]
    buffer_load_dwordx4 v181, s[8:11], 0 offen lds
    s_mov_b64 exec, -1
    s_add_u32 m0, s57, 0
    s_nop 0
    buffer_load_dwordx4 v180, s[36:39], 0 offen sc1 lds
    s_add_u32 m0, s57, 1024
    s_nop 0
    buffer_load_dwordx4 v182, s[36:39], 0 offen sc1 lds
    buffer_load_dwordx4 v[92:95], v246, s[32:35], s67 offen offset:3072 sc1
    s_cmp_le_u32 s54, 9
    s_cbranch_scc1 L_exit0
    s_waitcnt lgkmcnt(0)
    s_cbranch_vccnz L_nba8
    s_waitcnt vmcnt(8)
    s_barrier
L_nba8:
    v_mfma_f32_32x32x16_bf16 v[112:127], v[144:147], v[4:7], 0
    v_exp_f32 v128, v96
    v_exp_f32 v129, v97
    v_exp_f32 v130, v98
    v_mfma_f32_32x32x16_bf16 v[112:127], v[148:151], v[8:11], v[112:127]
    v_exp_f32 v131, v99
    v_exp_f32 v132, v100
    v_exp_f32 v133, v101
    v_exp_f32 v134, v102
    v_exp_f32 v135, v103
    v_pk_add_f32 v[128:129], v[128:129], 1.0 op_sel_hi:[1,0]
    v_pk_add_f32 v[130:131], v[130:131], 1.0 op_sel_hi:[1,0]
    v_pk_add_f32 v[132:133], v[132:133], 1.0 op_sel_hi:[1,0]
    v_pk_add_f32 v[134:135], v[134:135], 1.0 op_sel_hi:[1,0]
    v_mfma_f32_32x32x16_bf16 v[112:127], v[152:155], v[16:19], v[112:127]
    v_rcp_f32 v128, v128
    v_rcp_f32 v129, v129
    v_rcp_f32 v130, v130
    v_mfma_f32_32x32x16_bf16 v[112:127], v[156:159], v[20:23], v[112:127]
    v_rcp_f32 v131, v131
    v_rcp_f32 v132, v132
    v_rcp_f32 v133, v133
    v_rcp_f32 v134, v134
    v_rcp_f32 v135, v135
    v_pk_mul_f32 v[128:129], v[128:129], v[96:97]
    v_pk_mul_f32 v[130:131], v[130:131], v[98:99]
    v_pk_mul_f32 v[132:133], v[132:133], v[100:101]
    v_pk_mul_f32 v[134:135], v[134:135], v[102:103]
    v_mfma_f32_32x32x16_bf16 v[112:127], v[160:163], v[12:15], v[112:127]
    v_cvt_pk_bf16_f32 v172, v128, v129
    v_cvt_pk_bf16_f32 v173, v130, v131
    v_cvt_pk_bf16_f32 v174, v132, v133
    v_cvt_pk_bf16_f32 v175, v134, v135
    v_exp_f32 v136, v104
    v_exp_f32 v137, v105
    v_mfma_f32_32x32x16_bf16 v[24:39], v[172:175], v[164:167], v[24:39]
    v_exp_f32 v138, v106
    v_exp_f32 v139, v107
    v_exp_f32 v140, v108
    v_exp_f32 v141, v109
    v_exp_f32 v142, v110
    v_exp_f32 v143, v111
    v_pk_add_f32 v[136:137], v[136:137], 1.0 op_sel_hi:[1,0]
    v_pk_add_f32 v[138:139], v[138:139], 1.0 op_sel_hi:[1,0]
    v_pk_add_f32 v[140:141], v[140:141], 1.0 op_sel_hi:[1,0]
    v_pk_add_f32 v[142:143], v[142:143], 1.0 op_sel_hi:[1,0]
    v_rcp_f32 v136, v136
    v_rcp_f32 v137, v137
    v_rcp_f32 v138, v138
    v_rcp_f32 v139, v139
    v_rcp_f32 v140, v140
    v_rcp_f32 v141, v141
    v_rcp_f32 v142, v142
    v_rcp_f32 v143, v143
    v_pk_mul_f32 v[136:137], v[136:137], v[104:105]
    v_pk_mul_f32 v[138:139], v[138:139], v[106:107]
    v_pk_mul_f32 v[140:141], v[140:141], v[108:109]
    v_pk_mul_f32 v[142:143], v[142:143], v[110:111]
    v_cvt_pk_bf16_f32 v176, v136, v137
    v_cvt_pk_bf16_f32 v177, v138, v139
    v_cvt_pk_bf16_f32 v178, v140, v141
    v_cvt_pk_bf16_f32 v179, v142, v143
    s_nop 1
    v_mfma_f32_32x32x16_bf16 v[24:39], v[176:179], v[168:171], v[24:39]
    s_cbranch_vccz L_nbb8
    s_waitcnt vmcnt(8)
    s_barrier
L_nbb8:
    ds_read_b128 v[144:147], v216 offset:16384
    ds_read_b128 v[148:151], v217 offset:16384
    ds_read_b128 v[152:155], v218 offset:20480
    ds_read_b128 v[156:159], v219 offset:20480
    ds_read_b128 v[160:163], v241 offset:10240
    ds_read_b64_tr_b16 v[164:165], v220 offset:18432
    ds_read_b64_tr_b16 v[166:167], v221 offset:18432
    ds_read_b64_tr_b16 v[168:169], v220 offset:19456
    ds_read_b64_tr_b16 v[170:171], v221 offset:19456
    s_cmp_le_u32 s54, 10
    s_cbranch_scc1 L_exit1
    s_waitcnt lgkmcnt(0)
    s_cbranch_vccnz L_nba9
    s_waitcnt vmcnt(4)
    s_barrier
L_nba9:
    v_mfma_f32_32x32x16_bf16 v[96:111], v[144:147], v[4:7], 0
    v_exp_f32 v128, v112
    v_exp_f32 v129, v113
    v_exp_f32 v130, v114
    v_mfma_f32_32x32x16_bf16 v[96:111], v[148:151], v[8:11], v[96:111]
    v_exp_f32 v131, v115
    v_exp_f32 v132, v116
    v_exp_f32 v133, v117
    v_exp_f32 v134, v118
    v_exp_f32 v135, v119
    v_pk_add_f32 v[128:129], v[128:129], 1.0 op_sel_hi:[1,0]
    v_pk_add_f32 v[130:131], v[130:131], 1.0 op_sel_hi:[1,0]
    v_pk_add_f32 v[132:133], v[132:133], 1.0 op_sel_hi:[1,0]
    v_pk_add_f32 v[134:135], v[134:135], 1.0 op_sel_hi:[1,0]
    v_mfma_f32_32x32x16_bf16 v[96:111], v[152:155], v[16:19], v[96:111]
    v_rcp_f32 v128, v128
    v_rcp_f32 v129, v129
    v_rcp_f32 v130, v130
    v_mfma_f32_32x32x16_bf16 v[96:111], v[156:159], v[20:23], v[96:111]
    v_rcp_f32 v131, v131
    v_rcp_f32 v132, v132
    v_rcp_f32 v133, v133
    v_rcp_f32 v134, v134
    v_rcp_f32 v135, v135
    v_pk_mul_f32 v[128:129], v[128:129], v[112:113]
    v_pk_mul_f32 v[130:131], v[130:131], v[114:115]
    v_pk_mul_f32 v[132:133], v[132:133], v[116:117]
    v_pk_mul_f32 v[134:135], v[134:135], v[118:119]
    v_mfma_f32_32x32x16_bf16 v[96:111], v[160:163], v[12:15], v[96:111]
    v_cvt_pk_bf16_f32 v172, v128, v129
    v_cvt_pk_bf16_f32 v173, v130, v131
    v_cvt_pk_bf16_f32 v174, v132, v133
    v_cvt_pk_bf16_f32 v175, v134, v135
    v_exp_f32 v136, v120
    v_exp_f32 v137, v121
    v_mfma_f32_32x32x16_bf16 v[24:39], v[172:175], v[164:167], v[24:39]
    v_exp_f32 v138, v122
    v_exp_f32 v139, v123
    v_exp_f32 v140, v124
    v_exp_f32 v141, v125
    v_exp_f32 v142, v126
    v_exp_f32 v143, v127
    v_pk_add_f32 v[136:137], v[136:137], 1.0 op_sel_hi:[1,0]
    v_pk_add_f32 v[138:139], v[138:139], 1.0 op_sel_hi:[1,0]
    v_pk_add_f32 v[140:141], v[140:141], 1.0 op_sel_hi:[1,0]
    v_pk_add_f32 v[142:143], v[142:143], 1.0 op_sel_hi:[1,0]
    v_rcp_f32 v136, v136
    v_rcp_f32 v137, v137
    v_rcp_f32 v138, v138
    v_rcp_f32 v139, v139
    v_rcp_f32 v140, v140
    v_rcp_f32 v141, v141
    v_rcp_f32 v142, v142
    v_rcp_f32 v143, v143
    v_pk_mul_f32 v[136:137], v[136:137], v[120:121]
    v_pk_mul_f32 v[138:139], v[138:139], v[122:123]
    v_pk_mul_f32 v[140:141], v[140:141], v[124:125]
    v_pk_mul_f32 v[142:143], v[142:143], v[126:127]
    v_cvt_pk_bf16_f32 v176, v136, v137
    v_cvt_pk_bf16_f32 v177, v138, v139
    v_cvt_pk_bf16_f32 v178, v140, v141
    v_cvt_pk_bf16_f32 v179, v142, v143
    s_nop 1
    v_mfma_f32_32x32x16_bf16 v[24:39], v[176:179], v[168:171], v[24:39]
    s_cbranch_vccz L_nbb9
    s_waitcnt vmcnt(4)
    s_barrier
L_nbb9:
    ds_read_b128 v[144:147], v216 offset:24576
    ds_read_b128 v[148:151], v217 offset:24576
    ds_read_b128 v[152:155], v218 offset:22528
    ds_read_b128 v[156:159], v219 offset:22528
    ds_read_b128 v[160:163], v241 offset:11264
    ds_read_b64_tr_b16 v[164:165], v220 offset:20480
    ds_read_b64_tr_b16 v[166:167], v221 offset:20480
    ds_read_b64_tr_b16 v[168:169], v220 offset:21504
    ds_read_b64_tr_b16 v[170:171], v221 offset:21504
    s_cmp_le_u32 s54, 11
    s_cbranch_scc1 L_exit0
    s_waitcnt lgkmcnt(0)
    s_cbranch_vccnz L_nba10
    s_waitcnt vmcnt(0)
    s_barrier
L_nba10:
    v_mfma_f32_32x32x16_bf16 v[112:127], v[144:147], v[4:7], 0
    v_exp_f32 v128, v96
    v_exp_f32 v129, v97
    v_exp_f32 v130, v98
    v_mfma_f32_32x32x16_bf16 v[112:127], v[148:151], v[8:11], v[112:127]
    v_exp_f32 v131, v99
    v_exp_f32 v132, v100
    v_exp_f32 v133, v101
    v_exp_f32 v134, v102
    v_exp_f32 v135, v103
    v_pk_add_f32 v[128:129], v[128:129], 1.0 op_sel_hi:[1,0]
    v_pk_add_f32 v[130:131], v[130:131], 1.0 op_sel_hi:[1,0]
    v_pk_add_f32 v[132:133], v[132:133], 1.0 op_sel_hi:[1,0]
    v_pk_add_f32 v[134:135], v[134:135], 1.0 op_sel_hi:[1,0]
    v_mfma_f32_32x32x16_bf16 v[112:127], v[152:155], v[16:19], v[112:127]
    v_rcp_f32 v128, v128
    v_rcp_f32 v129, v129
    v_rcp_f32 v130, v130
    v_mfma_f32_32x32x16_bf16 v[112:127], v[156:159], v[20:23], v[112:127]
    v_rcp_f32 v131, v131
    v_rcp_f32 v132, v132
    v_rcp_f32 v133, v133
    v_rcp_f32 v134, v134
    v_rcp_f32 v135, v135
    v_pk_mul_f32 v[128:129], v[128:129], v[96:97]
    v_pk_mul_f32 v[130:131], v[130:131], v[98:99]
    v_pk_mul_f32 v[132:133], v[132:133], v[100:101]
    v_pk_mul_f32 v[134:135], v[134:135], v[102:103]
    v_mfma_f32_32x32x16_bf16 v[112:127], v[160:163], v[12:15], v[112:127]
    v_cvt_pk_bf16_f32 v172, v128, v129
    v_cvt_pk_bf16_f32 v173, v130, v131
    v_cvt_pk_bf16_f32 v174, v132, v133
    v_cvt_pk_bf16_f32 v175, v134, v135
    v_exp_f32 v136, v104
    v_exp_f32 v137, v105
    v_mfma_f32_32x32x16_bf16 v[24:39], v[172:175], v[164:167], v[24:39]
    v_exp_f32 v138, v106
    v_exp_f32 v139, v107
    v_exp_f32 v140, v108
    v_exp_f32 v141, v109
    v_exp_f32 v142, v110
    v_exp_f32 v143, v111
    v_pk_add_f32 v[136:137], v[136:137], 1.0 op_sel_hi:[1,0]
    v_pk_add_f32 v[138:139], v[138:139], 1.0 op_sel_hi:[1,0]
    v_pk_add_f32 v[140:141], v[140:141], 1.0 op_sel_hi:[1,0]
    v_pk_add_f32 v[142:143], v[142:143], 1.0 op_sel_hi:[1,0]
    v_rcp_f32 v136, v136
    v_rcp_f32 v137, v137
    v_rcp_f32 v138, v138
    v_rcp_f32 v139, v139
    v_rcp_f32 v140, v140
    v_rcp_f32 v141, v141
    v_rcp_f32 v142, v142
    v_rcp_f32 v143, v143
    v_pk_mul_f32 v[136:137], v[136:137], v[104:105]
    v_pk_mul_f32 v[138:139], v[138:139], v[106:107]
    v_pk_mul_f32 v[140:141], v[140:141], v[108:109]
    v_pk_mul_f32 v[142:143], v[142:143], v[110:111]
    v_cvt_pk_bf16_f32 v176, v136, v137
    v_cvt_pk_bf16_f32 v177, v138, v139
    v_cvt_pk_bf16_f32 v178, v140, v141
    v_cvt_pk_bf16_f32 v179, v142, v143
    s_nop 1
    v_mfma_f32_32x32x16_bf16 v[24:39], v[176:179], v[168:171], v[24:39]
    s_cbranch_vccz L_nbb10
    s_waitcnt vmcnt(0)
    s_barrier
L_nbb10:
    ds_read_b128 v[144:147], v216 offset:0
    ds_read_b128 v[148:151], v217 offset:0
    ds_read_b128 v[152:155], v218 offset:24576
    ds_read_b128 v[156:159], v219 offset:24576
    ds_read_b128 v[160:163], v241 offset:12288
    ds_read_b64_tr_b16 v[164:165], v220 offset:22528
    ds_read_b64_tr_b16 v[166:167], v221 offset:22528
    ds_read_b64_tr_b16 v[168:169], v220 offset:23552
    ds_read_b64_tr_b16 v[170:171], v221 offset:23552
    s_cmp_le_u32 s54, 12
    s_cbranch_scc1 L_exit1
    s_waitcnt lgkmcnt(0)
    s_cbranch_vccnz L_nba11
    s_waitcnt vmcnt(1)
    s_barrier
L_nba11:
    v_mfma_f32_32x32x16_bf16 v[96:111], v[144:147], v[4:7], 0
    v_exp_f32 v128, v112
    v_exp_f32 v129, v113
    v_exp_f32 v130, v114
    v_mfma_f32_32x32x16_bf16 v[96:111], v[148:151], v[8:11], v[96:111]
    v_exp_f32 v131, v115
    v_exp_f32 v132, v116
    v_exp_f32 v133, v117
    v_exp_f32 v134, v118
    v_exp_f32 v135, v119
    v_pk_add_f32 v[128:129], v[128:129], 1.0 op_sel_hi:[1,0]
    v_pk_add_f32 v[130:131], v[130:131], 1.0 op_sel_hi:[1,0]
    v_pk_add_f32 v[132:133], v[132:133], 1.0 op_sel_hi:[1,0]
    v_pk_add_f32 v[134:135], v[134:135], 1.0 op_sel_hi:[1,0]
    v_mfma_f32_32x32x16_bf16 v[96:111], v[152:155], v[16:19], v[96:111]
    v_rcp_f32 v128, v128
    v_rcp_f32 v129, v129
    v_rcp_f32 v130, v130
    v_mfma_f32_32x32x16_bf16 v[96:111], v[156:159], v[20:23], v[96:111]
    v_rcp_f32 v131, v131
    v_rcp_f32 v132, v132
    v_rcp_f32 v133, v133
    v_rcp_f32 v134, v134
    v_rcp_f32 v135, v135
    v_pk_mul_f32 v[128:129], v[128:129], v[112:113]
    v_pk_mul_f32 v[130:131], v[130:131], v[114:115]
    v_pk_mul_f32 v[132:133], v[132:133], v[116:117]
    v_pk_mul_f32 v[134:135], v[134:135], v[118:119]
    v_mfma_f32_32x32x16_bf16 v[96:111], v[160:163], v[12:15], v[96:111]
    v_cvt_pk_bf16_f32 v172, v128, v129
    v_cvt_pk_bf16_f32 v173, v130, v131
    v_cvt_pk_bf16_f32 v174, v132, v133
    v_cvt_pk_bf16_f32 v175, v134, v135
    v_exp_f32 v136, v120
    v_exp_f32 v137, v121
    v_mfma_f32_32x32x16_bf16 v[24:39], v[172:175], v[164:167], v[24:39]
    v_exp_f32 v138, v122
    v_exp_f32 v139, v123
    v_exp_f32 v140, v124
    v_exp_f32 v141, v125
    v_exp_f32 v142, v126
    v_exp_f32 v143, v127
    v_pk_add_f32 v[136:137], v[136:137], 1.0 op_sel_hi:[1,0]
    v_pk_add_f32 v[138:139], v[138:139], 1.0 op_sel_hi:[1,0]
    v_pk_add_f32 v[140:141], v[140:141], 1.0 op_sel_hi:[1,0]
    v_pk_add_f32 v[142:143], v[142:143], 1.0 op_sel_hi:[1,0]
    v_rcp_f32 v136, v136
    v_rcp_f32 v137, v137
    v_rcp_f32 v138, v138
    v_rcp_f32 v139, v139
    v_rcp_f32 v140, v140
    v_rcp_f32 v141, v141
    v_rcp_f32 v142, v142
    v_rcp_f32 v143, v143
    v_pk_mul_f32 v[136:137], v[136:137], v[120:121]
    v_pk_mul_f32 v[138:139], v[138:139], v[122:123]
    v_pk_mul_f32 v[140:141], v[140:141], v[124:125]
    v_pk_mul_f32 v[142:143], v[142:143], v[126:127]
    v_cvt_pk_bf16_f32 v176, v136, v137
    v_cvt_pk_bf16_f32 v177, v138, v139
    v_cvt_pk_bf16_f32 v178, v140, v141
    v_cvt_pk_bf16_f32 v179, v142, v143
    s_nop 1
    v_mfma_f32_32x32x16_bf16 v[24:39], v[176:179], v[168:171], v[24:39]
    s_cbranch_vccz L_nbb11
    s_waitcnt vmcnt(1)
    s_barrier
L_nbb11:
    ds_read_b64_tr_b16 v[164:165], v220 offset:24576
    ds_read_b64_tr_b16 v[166:167], v221 offset:24576
    ds_read_b64_tr_b16 v[168:169], v220 offset:25600
    ds_read_b64_tr_b16 v[170:171], v221 offset:25600
    s_branch L_exit0
L_exit0:
    v_exp_f32 v128, v96
    v_exp_f32 v129, v97
    v_exp_f32 v130, v98
    v_exp_f32 v131, v99
    v_exp_f32 v132, v100
    v_exp_f32 v133, v101
    v_exp_f32 v134, v102
    v_exp_f32 v135, v103
    v_pk_add_f32 v[128:129], v[128:129], 1.0 op_sel_hi:[1,0]
    v_pk_add_f32 v[130:131], v[130:131], 1.0 op_sel_hi:[1,0]
    v_pk_add_f32 v[132:133], v[132:133], 1.0 op_sel_hi:[1,0]
    v_pk_add_f32 v[134:135], v[134:135], 1.0 op_sel_hi:[1,0]
    v_rcp_f32 v128, v128
    v_rcp_f32 v129, v129
    v_rcp_f32 v130, v130
    v_rcp_f32 v131, v131
    v_rcp_f32 v132, v132
    v_rcp_f32 v133, v133
    v_rcp_f32 v134, v134
    v_rcp_f32 v135, v135
    v_pk_mul_f32 v[128:129], v[128:129], v[96:97]
    v_pk_mul_f32 v[130:131], v[130:131], v[98:99]
    v_pk_mul_f32 v[132:133], v[132:133], v[100:101]
    v_pk_mul_f32 v[134:135], v[134:135], v[102:103]
    v_cvt_pk_bf16_f32 v172, v128, v129
    v_cvt_pk_bf16_f32 v173, v130, v131
    v_cvt_pk_bf16_f32 v174, v132, v133
    v_cvt_pk_bf16_f32 v175, v134, v135
    s_waitcnt lgkmcnt(0)
    s_cmp_le_i32 s47, -16
    v_mfma_f32_32x32x16_bf16 v[24:39], v[172:175], v[164:167], v[24:39]
    s_cbranch_scc1 L_extra
    v_exp_f32 v136, v104
    v_exp_f32 v137, v105
    v_exp_f32 v138, v106
    v_exp_f32 v139, v107
    v_exp_f32 v140, v108
    v_exp_f32 v141, v109
    v_exp_f32 v142, v110
    v_exp_f32 v143, v111
    v_pk_add_f32 v[136:137], v[136:137], 1.0 op_sel_hi:[1,0]
    v_pk_add_f32 v[138:139], v[138:139], 1.0 op_sel_hi:[1,0]
    v_pk_add_f32 v[140:141], v[140:141], 1.0 op_sel_hi:[1,0]
    v_pk_add_f32 v[142:143], v[142:143], 1.0 op_sel_hi:[1,0]
    v_rcp_f32 v136, v136
    v_rcp_f32 v137, v137
    v_rcp_f32 v138, v138
    v_rcp_f32 v139, v139
    v_rcp_f32 v140, v140
    v_rcp_f32 v141, v141
    v_rcp_f32 v142, v142
    v_rcp_f32 v143, v143
    v_pk_mul_f32 v[136:137], v[136:137], v[104:105]
    v_pk_mul_f32 v[138:139], v[138:139], v[106:107]
    v_pk_mul_f32 v[140:141], v[140:141], v[108:109]
    v_pk_mul_f32 v[142:143], v[142:143], v[110:111]
    v_cvt_pk_bf16_f32 v176, v136, v137
    v_cvt_pk_bf16_f32 v177, v138, v139
    v_cvt_pk_bf16_f32 v178, v140, v141
    v_cvt_pk_bf16_f32 v179, v142, v143
    s_nop 1
    v_mfma_f32_32x32x16_bf16 v[24:39], v[176:179], v[168:171], v[24:39]
    s_branch L_extra
L_exit1:
    v_exp_f32 v128, v112
    v_exp_f32 v129, v113
    v_exp_f32 v130, v114
    v_exp_f32 v131, v115
    v_exp_f32 v132, v116
    v_exp_f32 v133, v117
    v_exp_f32 v134, v118
    v_exp_f32 v135, v119
    v_pk_add_f32 v[128:129], v[128:129], 1.0 op_sel_hi:[1,0]
    v_pk_add_f32 v[130:131], v[130:131], 1.0 op_sel_hi:[1,0]
    v_pk_add_f32 v[132:133], v[132:133], 1.0 op_sel_hi:[1,0]
    v_pk_add_f32 v[134:135], v[134:135], 1.0 op_sel_hi:[1,0]
    v_rcp_f32 v128, v128
    v_rcp_f32 v129, v129
    v_rcp_f32 v130, v130
    v_rcp_f32 v131, v131
    v_rcp_f32 v132, v132
    v_rcp_f32 v133, v133
    v_rcp_f32 v134, v134
    v_rcp_f32 v135, v135
    v_pk_mul_f32 v[128:129], v[128:129], v[112:113]
    v_pk_mul_f32 v[130:131], v[130:131], v[114:115]
    v_pk_mul_f32 v[132:133], v[132:133], v[116:117]
    v_pk_mul_f32 v[134:135], v[134:135], v[118:119]
    v_cvt_pk_bf16_f32 v172, v128, v129
    v_cvt_pk_bf16_f32 v173, v130, v131
    v_cvt_pk_bf16_f32 v174, v132, v133
    v_cvt_pk_bf16_f32 v175, v134, v135
    s_waitcnt lgkmcnt(0)
    s_cmp_le_i32 s47, -16
    v_mfma_f32_32x32x16_bf16 v[24:39], v[172:175], v[164:167], v[24:39]
    s_cbranch_scc1 L_extra
    v_exp_f32 v136, v120
    v_exp_f32 v137, v121
    v_exp_f32 v138, v122
    v_exp_f32 v139, v123
    v_exp_f32 v140, v124
    v_exp_f32 v141, v125
    v_exp_f32 v142, v126
    v_exp_f32 v143, v127
    v_pk_add_f32 v[136:137], v[136:137], 1.0 op_sel_hi:[1,0]
    v_pk_add_f32 v[138:139], v[138:139], 1.0 op_sel_hi:[1,0]
    v_pk_add_f32 v[140:141], v[140:141], 1.0 op_sel_hi:[1,0]
    v_pk_add_f32 v[142:143], v[142:143], 1.0 op_sel_hi:[1,0]
    v_rcp_f32 v136, v136
    v_rcp_f32 v137, v137
    v_rcp_f32 v138, v138
    v_rcp_f32 v139, v139
    v_rcp_f32 v140, v140
    v_rcp_f32 v141, v141
    v_rcp_f32 v142, v142
    v_rcp_f32 v143, v143
    v_pk_mul_f32 v[136:137], v[136:137], v[120:121]
    v_pk_mul_f32 v[138:139], v[138:139], v[122:123]
    v_pk_mul_f32 v[140:141], v[140:141], v[124:125]
    v_pk_mul_f32 v[142:143], v[142:143], v[126:127]
    v_cvt_pk_bf16_f32 v176, v136, v137
    v_cvt_pk_bf16_f32 v177, v138, v139
    v_cvt_pk_bf16_f32 v178, v140, v141
    v_cvt_pk_bf16_f32 v179, v142, v143
    s_nop 1
    v_mfma_f32_32x32x16_bf16 v[24:39], v[176:179], v[168:171], v[24:39]
L_extra:
    s_cmp_eq_u32 s55, 0
    s_cbranch_scc1 L_rdone
    s_barrier
    s_sub_u32 s55, s55, 1
    s_branch L_extra
L_rdone:
    s_or_b32 s46, s58, s59
    s_or_b32 s46, s46, s60
    s_max_i32 s44, s52, s53
    s_max_i32 s44, s44, 0
    s_or_b32 s46, s46, s44
    s_cbranch_scc1 L_more
    s_cmp_le_i32 s56, 160
    s_cbranch_scc1 L_agbar
L_ag:
    s_mul_i32 s46, s41, 26624
    s_lshl_b32 s45, s43, 11
    s_add_u32 s46, s46, s45
    s_add_u32 s46, s46, 92160
    v_add_u32 v209, s46, v245
    v_cvt_pk_bf16_f32 v172, v24, v25
    v_cvt_pk_bf16_f32 v173, v26, v27
    v_cvt_pk_bf16_f32 v174, v28, v29
    v_cvt_pk_bf16_f32 v175, v30, v31
    v_cvt_pk_bf16_f32 v176, v32, v33
    v_cvt_pk_bf16_f32 v177, v34, v35
    v_cvt_pk_bf16_f32 v178, v36, v37
    v_cvt_pk_bf16_f32 v179, v38, v39
    ds_write_b128 v209, v[172:175]
    ds_write_b128 v209, v[176:179] offset:1024
    s_lshl_b32 s46, s40, 10
    s_add_u32 s46, s46, 153600
    v_add_u32 v208, s46, v245
    v_mov_b32 v210, s62
    s_waitcnt vmcnt(0) lgkmcnt(0)
    s_barrier
    ds_read_b128 v[96:99], v235 offset:0
    ds_read_b128 v[100:103], v235 offset:2048
    ds_read_b128 v[104:107], v235 offset:4096
    ds_read_b128 v[108:111], v235 offset:6144
    ds_read_b128 v[112:115], v236 offset:0
    ds_read_b128 v[116:119], v236 offset:2048
    ds_read_b128 v[120:123], v236 offset:4096
    ds_read_b128 v[124:127], v236 offset:6144
    ds_read_b128 v[128:131], v237 offset:0
    ds_read_b128 v[132:135], v237 offset:2048
    ds_read_b128 v[136:139], v237 offset:4096
    ds_read_b128 v[140:143], v237 offset:6144
    s_waitcnt lgkmcnt(11)
    v_mfma_f32_16x16x32_bf16 v[40:43], v[80:83], v[96:99], v[40:43]
    s_waitcnt lgkmcnt(10)
    v_mfma_f32_16x16x32_bf16 v[40:43], v[84:87], v[100:103], v[40:43]
    s_waitcnt lgkmcnt(9)
    v_mfma_f32_16x16x32_bf16 v[40:43], v[88:91], v[104:107], v[40:43]
    s_waitcnt lgkmcnt(8)
    v_mfma_f32_16x16x32_bf16 v[40:43], v[92:95], v[108:111], v[40:43]
    s_waitcnt lgkmcnt(7)
    v_mfma_f32_16x16x32_bf16 v[44:47], v[80:83], v[112:115], v[44:47]
    s_waitcnt lgkmcnt(6)
    v_mfma_f32_16x16x32_bf16 v[44:47], v[84:87], v[116:119], v[44:47]
    s_waitcnt lgkmcnt(5)
    v_mfma_f32_16x16x32_bf16 v[44:47], v[88:91], v[120:123], v[44:47]
    s_waitcnt lgkmcnt(4)
    v_mfma_f32_16x16x32_bf16 v[44:47], v[92:95], v[124:127], v[44:47]
    s_waitcnt lgkmcnt(3)
    v_mfma_f32_16x16x32_bf16 v[48:51], v[80:83], v[128:131], v[48:51]
    v_exp_f32 v144, v40
    s_waitcnt lgkmcnt(2)
    v_mfma_f32_16x16x32_bf16 v[48:51], v[84:87], v[132:135], v[48:51]
    v_exp_f32 v145, v41
    s_waitcnt lgkmcnt(1)
    v_mfma_f32_16x16x32_bf16 v[48:51], v[88:91], v[136:139], v[48:51]
    v_exp_f32 v146, v42
    s_waitcnt lgkmcnt(0)
    v_mfma_f32_16x16x32_bf16 v[48:51], v[92:95], v[140:143], v[48:51]
    v_exp_f32 v147, v43
    v_fma_f32 v144, v144, v210, v210
    v_fma_f32 v145, v145, v210, v210
    v_fma_f32 v146, v146, v210, v210
    v_fma_f32 v147, v147, v210, v210
    v_rcp_f32 v144, v144
    v_rcp_f32 v145, v145
    v_rcp_f32 v146, v146
    v_rcp_f32 v147, v147
    v_mul_f32 v144, v144, v40
    v_mul_f32 v145, v145, v41
    v_mul_f32 v146, v146, v42
    v_mul_f32 v147, v147, v43
    v_cvt_pk_bf16_f32 v172, v144, v145
    v_cvt_pk_bf16_f32 v173, v146, v147
    ds_write_b64 v238, v[172:173]
    v_exp_f32 v148, v44
    v_exp_f32 v149, v45
    v_exp_f32 v150, v46
    v_exp_f32 v151, v47
    v_fma_f32 v148, v148, v210, v210
    v_fma_f32 v149, v149, v210, v210
    v_fma_f32 v150, v150, v210, v210
    v_fma_f32 v151, v151, v210, v210
    v_rcp_f32 v148, v148
    v_rcp_f32 v149, v149
    v_rcp_f32 v150, v150
    v_rcp_f32 v151, v151
    v_mul_f32 v148, v148, v44
    v_mul_f32 v149, v149, v45
    v_mul_f32 v150, v150, v46
    v_mul_f32 v151, v151, v47
    v_cvt_pk_bf16_f32 v174, v148, v149
    v_cvt_pk_bf16_f32 v175, v150, v151
    ds_write_b64 v239, v[174:175]
    v_exp_f32 v152, v48
    v_exp_f32 v153, v49
    v_exp_f32 v154, v50
    v_exp_f32 v155, v51
    v_fma_f32 v152, v152, v210, v210
    v_fma_f32 v153, v153, v210, v210
    v_fma_f32 v154, v154, v210, v210
    v_fma_f32 v155, v155, v210, v210
    v_rcp_f32 v152, v152
    v_rcp_f32 v153, v153
    v_rcp_f32 v154, v154
    v_rcp_f32 v155, v155
    v_mul_f32 v152, v152, v48
    v_mul_f32 v153, v153, v49
    v_mul_f32 v154, v154, v50
    v_mul_f32 v155, v155, v51
    v_cvt_pk_bf16_f32 v176, v152, v153
    v_cvt_pk_bf16_f32 v177, v154, v155
    ds_write_b64 v240, v[176:177]
    s_cmp_eq_u32 s2, 0
    s_cbranch_scc0 L_nononce
    v_mov_b32 v211, 0
    v_mov_b32 v212, s61
    buffer_store_dword v212, v211, s[32:35], 0 offen
L_nononce:
    s_waitcnt lgkmcnt(0)
    s_barrier
    ds_read_b128 v[96:99], v208
    s_cmp_lt_u32 s40, 2
    s_cbranch_scc0 L_st1
    ds_read_b128 v[100:103], v208 offset:8192
    s_waitcnt lgkmcnt(0)
    buffer_store_dwordx4 v[100:103], v225, s[28:31], s70 offen
L_st1:
    s_waitcnt lgkmcnt(0)
    buffer_store_dwordx4 v[96:99], v224, s[28:31], s70 offen
L_end:
    s_endpgm
L_role02:
    s_cmp_eq_u32 s3, 0
    s_cbranch_scc0 L_role2
    s_waitcnt lgkmcnt(0)
    s_barrier
    buffer_load_dwordx4 v[204:207], v245, s[32:35], s74 offen sc1
    buffer_load_dword v244, v62, s[32:35], s74 offen offset:1024 sc1
    s_waitcnt vmcnt(0)
    s_branch L_common
L_role2:
    s_cmp_lt_u32 s65, 4
    s_cselect_b32 s46, 3, 2
    s_cselect_b32 s44, 1, 2
    s_lshl_b32 s44, s44, 10
    v_lshlrev_b32 v208, s46, v43
    v_lshl_add_u32 v208, v40, 4, v208
    v_add_u32 v208, v208, v44
    s_lshl_b32 s46, s40, 1
    v_add_u32 v209, s46, v50
    v_xor_b32 v209, v209, v51
    v_lshlrev_b32 v209, 4, v209
    v_lshl_add_u32 v209, v49, 3, v209
    v_lshl_add_u32 v211, v208, 8, v209
    v_add_u32 v212, s44, v211
    s_lshl_b32 s46, s40, 13
    s_lshl_b32 s44, s65, 10
    s_add_u32 s46, s46, s44
    s_add_u32 s46, s46, 3145728
    s_waitcnt vmcnt(6) lgkmcnt(0)
    s_add_u32 s61, s61, 1
    s_barrier
    s_cmp_gt_u32 s65, 7
    s_cbranch_scc1 L_r3
    ds_read_b64_tr_b16 v[172:173], v211
    ds_read_b64_tr_b16 v[174:175], v212
    s_waitcnt lgkmcnt(0)
    buffer_store_dwordx4 v[172:175], v245, s[32:35], s46 offen sc1
L_r3:
    s_waitcnt vmcnt(0)
    s_cmp_eq_u32 s42, 0
    s_cbranch_scc1 L_arr2
    s_mov_b32 s42, 0
    s_mov_b64 exec, 1
    v_mov_b32 v212, 153584
    v_mov_b32 v208, 1
    ds_add_rtn_u32 v208, v212, v208
    s_sub_u32 s53, s2, 80
    s_lshl_b32 s53, s53, 7
    s_add_u32 s53, s53, 4096
    v_mov_b32 v209, s61
    s_waitcnt lgkmcnt(0)
    v_readfirstlane_b32 s52, v208
    s_nop 0
    s_cmp_eq_u32 s52, 7
    s_cbranch_scc0 L_arrx2
    buffer_store_dword v209, v1, s[32:35], s53 offen sc1
L_arrx2:
    s_mov_b64 exec, -1
L_arr2:
    buffer_load_dwordx4 v[204:207], v245, s[32:35], s74 offen sc1
    buffer_load_dword v244, v62, s[32:35], s74 offen offset:1024 sc1
    s_waitcnt vmcnt(0)
    s_branch L_common
L_repoll:
    s_waitcnt vmcnt(0)
    s_cmp_eq_u32 s42, 0
    s_cbranch_scc1 L_arr1
    s_mov_b32 s42, 0
    s_mov_b64 exec, 1
    v_mov_b32 v212, 153584
    v_mov_b32 v208, 1
    ds_add_rtn_u32 v208, v212, v208
    s_sub_u32 s53, s2, 80
    s_lshl_b32 s53, s53, 7
    s_add_u32 s53, s53, 4096
    v_mov_b32 v209, s61
    s_waitcnt lgkmcnt(0)
    v_readfirstlane_b32 s52, v208
    s_nop 0
    s_cmp_eq_u32 s52, 7
    s_cbranch_scc0 L_arrx1
    buffer_store_dword v209, v1, s[32:35], s53 offen sc1
L_arrx1:
    s_mov_b64 exec, -1
L_arr1:
    s_lshr_b64 s[48:49], s[44:45], 4
    s_or_b64 s[44:45], s[44:45], s[48:49]
    s_lshr_b64 s[48:49], s[44:45], 2
    s_or_b64 s[44:45], s[44:45], s[48:49]
    s_lshr_b64 s[48:49], s[44:45], 1
    s_or_b64 s[44:45], s[44:45], s[48:49]
    s_and_b32 s44, s44, 0x01010101
    s_mul_i32 s44, s44, 255
    s_and_b32 s45, s45, 0x01010101
    s_mul_i32 s45, s45, 255
    s_and_b64 exec, s[44:45], s[44:45]
    s_cbranch_scc0 L_rp1
    buffer_load_dwordx4 v[204:207], v245, s[32:35], s74 offen sc1
L_rp1:
    s_cmp_lg_u32 vcc_lo, 0
    s_cselect_b32 exec_lo, -1, 0
    s_cmp_lg_u32 vcc_hi, 0
    s_cselect_b32 exec_hi, -1, 0
    s_cbranch_execz L_rp2
    buffer_load_dword v244, v62, s[32:35], s74 offen offset:1024 sc1
L_rp2:
    s_mov_b64 exec, -1
    s_sub_u32 s65, s65, 1
    s_waitcnt vmcnt(0)
    s_cbranch_scc0 L_poll
    s_endpgm
L_repollf:
    s_mov_b64 exec, vcc
    buffer_load_dword v48, v63, s[32:35], s75 offen sc1
    s_mov_b64 exec, -1
    s_sub_u32 s65, s65, 1
    s_waitcnt vmcnt(0)
    s_cbranch_scc0 L_pollf
    s_endpgm
L_exit0s:
    buffer_load_dwordx4 v[64:67], v245, s[32:35], s67 offen offset:0 sc1
    buffer_load_dwordx4 v[68:71], v245, s[32:35], s67 offen offset:1024 sc1
    buffer_load_dwordx4 v[72:75], v245, s[32:35], s67 offen offset:2048 sc1
    buffer_load_dwordx4 v[76:79], v245, s[32:35], s67 offen offset:3072 sc1
    buffer_load_dwordx4 v[80:83], v246, s[32:35], s67 offen offset:0 sc1
    buffer_load_dwordx4 v[84:87], v246, s[32:35], s67 offen offset:1024 sc1
    buffer_load_dwordx4 v[88:91], v246, s[32:35], s67 offen offset:2048 sc1
    buffer_load_dwordx4 v[92:95], v246, s[32:35], s67 offen offset:3072 sc1
    s_waitcnt vmcnt(0) lgkmcnt(0)
    v_xor_b32 v208, 0, v232
    ds_read_b128 v[52:55], v208
    v_xor_b32 v209, 0, v233
    ds_read_b128 v[56:59], v209
    v_xor_b32 v210, 0, v234
    ds_read_b128 v[60:63], v210
    s_waitcnt lgkmcnt(0)
    v_mfma_f32_16x16x32_bf16 v[40:43], v[64:67], v[52:55], 0
    v_mfma_f32_16x16x32_bf16 v[44:47], v[64:67], v[56:59], 0
    v_mfma_f32_16x16x32_bf16 v[48:51], v[64:67], v[60:63], 0
    v_xor_b32 v208, 64, v232
    ds_read_b128 v[52:55], v208
    v_xor_b32 v209, 64, v233
    ds_read_b128 v[56:59], v209
    v_xor_b32 v210, 64, v234
    ds_read_b128 v[60:63], v210
    s_waitcnt lgkmcnt(0)
    v_mfma_f32_16x16x32_bf16 v[40:43], v[68:71], v[52:55], v[40:43]
    v_mfma_f32_16x16x32_bf16 v[44:47], v[68:71], v[56:59], v[44:47]
    v_mfma_f32_16x16x32_bf16 v[48:51], v[68:71], v[60:63], v[48:51]
    v_xor_b32 v208, 128, v232
    ds_read_b128 v[52:55], v208
    v_xor_b32 v209, 128, v233
    ds_read_b128 v[56:59], v209
    v_xor_b32 v210, 128, v234
    ds_read_b128 v[60:63], v210
    s_waitcnt lgkmcnt(0)
    v_mfma_f32_16x16x32_bf16 v[40:43], v[72:75], v[52:55], v[40:43]
    v_mfma_f32_16x16x32_bf16 v[44:47], v[72:75], v[56:59], v[44:47]
    v_mfma_f32_16x16x32_bf16 v[48:51], v[72:75], v[60:63], v[48:51]
    v_xor_b32 v208, 192, v232
    ds_read_b128 v[52:55], v208
    v_xor_b32 v209, 192, v233
    ds_read_b128 v[56:59], v209
    v_xor_b32 v210, 192, v234
    ds_read_b128 v[60:63], v210
    s_waitcnt lgkmcnt(0)
    v_mfma_f32_16x16x32_bf16 v[40:43], v[76:79], v[52:55], v[40:43]
    v_mfma_f32_16x16x32_bf16 v[44:47], v[76:79], v[56:59], v[44:47]
    v_mfma_f32_16x16x32_bf16 v[48:51], v[76:79], v[60:63], v[48:51]
    s_nop 5
    v_pk_mul_f32 v[40:41], v[40:41], s[62:63]
    v_pk_mul_f32 v[42:43], v[42:43], s[62:63]
    v_pk_mul_f32 v[44:45], v[44:45], s[62:63]
    v_pk_mul_f32 v[46:47], v[46:47], s[62:63]
    v_pk_mul_f32 v[48:49], v[48:49], s[62:63]
    v_pk_mul_f32 v[50:51], v[50:51], s[62:63]
    s_branch L_exit0
L_exit1s:
    buffer_load_dwordx4 v[64:67], v245, s[32:35], s67 offen offset:0 sc1
    buffer_load_dwordx4 v[68:71], v245, s[32:35], s67 offen offset:1024 sc1
    buffer_load_dwordx4 v[72:75], v245, s[32:35], s67 offen offset:2048 sc1
    buffer_load_dwordx4 v[76:79], v245, s[32:35], s67 offen offset:3072 sc1
    buffer_load_dwordx4 v[80:83], v246, s[32:35], s67 offen offset:0 sc1
    buffer_load_dwordx4 v[84:87], v246, s[32:35], s67 offen offset:1024 sc1
    buffer_load_dwordx4 v[88:91], v246, s[32:35], s67 offen offset:2048 sc1
    buffer_load_dwordx4 v[92:95], v246, s[32:35], s67 offen offset:3072 sc1
    s_waitcnt vmcnt(0) lgkmcnt(0)
    v_xor_b32 v208, 0, v232
    ds_read_b128 v[52:55], v208
    v_xor_b32 v209, 0, v233
    ds_read_b128 v[56:59], v209
    v_xor_b32 v210, 0, v234
    ds_read_b128 v[60:63], v210
    s_waitcnt lgkmcnt(0)
    v_mfma_f32_16x16x32_bf16 v[40:43], v[64:67], v[52:55], 0
    v_mfma_f32_16x16x32_bf16 v[44:47], v[64:67], v[56:59], 0
    v_mfma_f32_16x16x32_bf16 v[48:51], v[64:67], v[60:63], 0
    v_xor_b32 v208, 64, v232
    ds_read_b128 v[52:55], v208
    v_xor_b32 v209, 64, v233
    ds_read_b128 v[56:59], v209
    v_xor_b32 v210, 64, v234
    ds_read_b128 v[60:63], v210
    s_waitcnt lgkmcnt(0)
    v_mfma_f32_16x16x32_bf16 v[40:43], v[68:71], v[52:55], v[40:43]
    v_mfma_f32_16x16x32_bf16 v[44:47], v[68:71], v[56:59], v[44:47]
    v_mfma_f32_16x16x32_bf16 v[48:51], v[68:71], v[60:63], v[48:51]
    v_xor_b32 v208, 128, v232
    ds_read_b128 v[52:55], v208
    v_xor_b32 v209, 128, v233
    ds_read_b128 v[56:59], v209
    v_xor_b32 v210, 128, v234
    ds_read_b128 v[60:63], v210
    s_waitcnt lgkmcnt(0)
    v_mfma_f32_16x16x32_bf16 v[40:43], v[72:75], v[52:55], v[40:43]
    v_mfma_f32_16x16x32_bf16 v[44:47], v[72:75], v[56:59], v[44:47]
    v_mfma_f32_16x16x32_bf16 v[48:51], v[72:75], v[60:63], v[48:51]
    v_xor_b32 v208, 192, v232
    ds_read_b128 v[52:55], v208
    v_xor_b32 v209, 192, v233
    ds_read_b128 v[56:59], v209
    v_xor_b32 v210, 192, v234
    ds_read_b128 v[60:63], v210
    s_waitcnt lgkmcnt(0)
    v_mfma_f32_16x16x32_bf16 v[40:43], v[76:79], v[52:55], v[40:43]
    v_mfma_f32_16x16x32_bf16 v[44:47], v[76:79], v[56:59], v[44:47]
    v_mfma_f32_16x16x32_bf16 v[48:51], v[76:79], v[60:63], v[48:51]
    s_nop 5
    v_pk_mul_f32 v[40:41], v[40:41], s[62:63]
    v_pk_mul_f32 v[42:43], v[42:43], s[62:63]
    v_pk_mul_f32 v[44:45], v[44:45], s[62:63]
    v_pk_mul_f32 v[46:47], v[46:47], s[62:63]
    v_pk_mul_f32 v[48:49], v[48:49], s[62:63]
    v_pk_mul_f32 v[50:51], v[50:51], s[62:63]
    s_branch L_exit1
L_agbar:
    s_waitcnt lgkmcnt(0)
    s_barrier
    s_branch L_ag
L_bin_ovf:
    s_waitcnt lgkmcnt(0)
    s_barrier
    ds_read_b32 v82, v80 offset:24576
    v_mov_b32 v72, 0
    ds_write_b32 v53, v72
    v_cmp_gt_u32 vcc, 256, v0
    s_nop 0
    s_mov_b64 exec, vcc
    s_waitcnt lgkmcnt(0)
    v_cmp_lt_u32 vcc, 24, v82
    v_lshlrev_b32 v82, 5, v0
    v_mov_b32 v84, -2
    v_mov_b32 v85, -2
    v_mov_b32 v86, -2
    v_mov_b32 v87, -2
    s_mov_b64 exec, vcc
    ds_write_b128 v82, v[84:87] offset:0
    ds_write_b128 v82, v[84:87] offset:16
    ds_write_b128 v82, v[84:87] offset:8192
    ds_write_b128 v82, v[84:87] offset:8208
    ds_write_b128 v82, v[84:87] offset:16384
    ds_write_b128 v82, v[84:87] offset:16400
    s_mov_b64 exec, -1
    s_waitcnt lgkmcnt(0)
    s_barrier
    s_branch L_bin_out
L_markov:
    s_mul_i32 s44, s40, 10
    v_lshrrev_b32 v209, 3, v1
    v_add_u32 v209, s44, v209
    v_add_u32 v209, 0, v209
    v_lshrrev_b32 v210, 5, v209
    v_lshlrev_b32 v210, 2, v210
    v_add_u32 v210, 153572, v210
    v_lshlrev_b32_e64 v211, v209, 1
    v_cmp_eq_u32 vcc, -2, v204
    s_nop 0
    s_mov_b64 exec, vcc
    ds_or_b32 v210, v211
    s_mov_b64 exec, -1
    v_lshrrev_b32 v209, 5, v1
    v_add_u32 v209, s44, v209
    v_add_u32 v209, 8, v209
    v_lshrrev_b32 v210, 5, v209
    v_lshlrev_b32 v210, 2, v210
    v_add_u32 v210, 153572, v210
    v_lshlrev_b32_e64 v211, v209, 1
    v_cmp_eq_u32 vcc, -2, v244
    s_nop 0
    s_mov_b64 exec, vcc
    ds_or_b32 v210, v211
    s_mov_b64 exec, -1
    s_branch L_count
L_more:
    s_cmp_eq_u32 s44, 0
    s_cbranch_scc1 L_rescan
    s_waitcnt vmcnt(0) lgkmcnt(0)
    s_barrier
    v_mov_b32 v128, 0
    v_mov_b32 v129, 0
    v_mov_b32 v130, 0
    v_mov_b32 v131, 0
    v_add_u32 v136, 92160, v248
    v_cmp_gt_u32 vcc, 510, v0
    v_mov_b32 v132, 0x7fffff
    ds_write_b128 v136, v[128:131] offset:0
    ds_write_b128 v136, v[128:131] offset:8192
    ds_write_b128 v136, v[128:131] offset:16384
    ds_write_b128 v136, v[128:131] offset:24576
    ds_write_b128 v136, v[128:131] offset:32768
    ds_write_b128 v136, v[128:131] offset:40960
    s_cmp_eq_u32 s41, 0
    s_cbranch_scc0 L_li1
    ds_write_b128 v136, v[128:131] offset:49152
L_li1:
    v_mov_b32 v133, v132
    v_mov_b32 v134, v132
    v_mov_b32 v135, v132
    s_mov_b64 exec, vcc
    ds_write_b128 v136, v[132:135] offset:53248
    s_mov_b64 exec, -1
    s_waitcnt lgkmcnt(0)
    s_barrier
    s_branch L_round
L_rescan:
    s_ff1_i32_b32 s46, s58
    s_cmp_lt_i32 s46, 0
    s_cbranch_scc1 L_rs0
    s_bitset0_b32 s58, s46
    s_add_u32 s46, s46, 0
    s_branch L_rsgo
L_rs0:
    s_ff1_i32_b32 s46, s59
    s_cmp_lt_i32 s46, 0
    s_cbranch_scc1 L_rs1
    s_bitset0_b32 s59, s46
    s_add_u32 s46, s46, 32
    s_branch L_rsgo
L_rs1:
    s_ff1_i32_b32 s46, s60
    s_cmp_lt_i32 s46, 0
    s_cbranch_scc1 L_rs2
    s_bitset0_b32 s60, s46
    s_add_u32 s46, s46, 64
    s_branch L_rsgo
L_rs2:
L_rsgo:
    s_mul_i32 s44, s46, 2000
    v_mov_b32 v230, s44
    v_mov_b32 v231, s44
    s_lshl_b32 s44, s44, 2
    s_waitcnt vmcnt(0) lgkmcnt(0)
    buffer_load_dwordx4 v[96:99], v248, s[16:19], s44 offen
    buffer_load_dwordx4 v[100:103], v248, s[12:15], s44 offen
    s_barrier
    v_mov_b32 v128, 0
    v_mov_b32 v129, 0
    v_mov_b32 v130, 0
    v_mov_b32 v131, 0
    v_add_u32 v136, 92160, v248
    v_cmp_gt_u32 vcc, 510, v0
    v_mov_b32 v132, 0x7fffff
    ds_write_b128 v136, v[128:131] offset:0
    ds_write_b128 v136, v[128:131] offset:8192
    ds_write_b128 v136, v[128:131] offset:16384
    ds_write_b128 v136, v[128:131] offset:24576
    ds_write_b128 v136, v[128:131] offset:32768
    ds_write_b128 v136, v[128:131] offset:40960
    s_cmp_eq_u32 s41, 0
    s_cbranch_scc0 L_li2
    ds_write_b128 v136, v[128:131] offset:49152
L_li2:
    v_cndmask_b32 v132, 0, v132, vcc
    v_mov_b32 v133, v132
    v_mov_b32 v134, v132
    v_mov_b32 v135, v132
    ds_write_b128 v136, v[132:135] offset:53248
    s_waitcnt vmcnt(0)
    v_lshlrev_b32 v209, 22, v0
    v_mov_b32 v211, 500
    v_lshrrev_b32 v210, 8, v96
    v_lshl_or_b32 v210, v100, 6, v210
    v_add_u32 v212, 0, v209
    v_or_b32 v210, v210, v212
    v_and_b32 v212, 255, v96
    v_cmp_eq_u32 vcc, s2, v212
    s_nop 1
    v_cndmask_b32 v210, -1, v210, vcc
    v_cmp_gt_u32 vcc, v211, v0
    s_nop 1
    v_cndmask_b32 v204, -1, v210, vcc
    v_lshrrev_b32 v210, 8, v97
    v_lshl_or_b32 v210, v101, 6, v210
    v_add_u32 v212, 1048576, v209
    v_or_b32 v210, v210, v212
    v_and_b32 v212, 255, v97
    v_cmp_eq_u32 vcc, s2, v212
    s_nop 1
    v_cndmask_b32 v210, -1, v210, vcc
    v_cmp_gt_u32 vcc, v211, v0
    s_nop 1
    v_cndmask_b32 v205, -1, v210, vcc
    v_lshrrev_b32 v210, 8, v98
    v_lshl_or_b32 v210, v102, 6, v210
    v_add_u32 v212, 2097152, v209
    v_or_b32 v210, v210, v212
    v_and_b32 v212, 255, v98
    v_cmp_eq_u32 vcc, s2, v212
    s_nop 1
    v_cndmask_b32 v210, -1, v210, vcc
    v_cmp_gt_u32 vcc, v211, v0
    s_nop 1
    v_cndmask_b32 v206, -1, v210, vcc
    v_lshrrev_b32 v210, 8, v99
    v_lshl_or_b32 v210, v103, 6, v210
    v_add_u32 v212, 3145728, v209
    v_or_b32 v210, v210, v212
    v_and_b32 v212, 255, v99
    v_cmp_eq_u32 vcc, s2, v212
    s_nop 1
    v_cndmask_b32 v210, -1, v210, vcc
    v_cmp_gt_u32 vcc, v211, v0
    s_nop 1
    v_cndmask_b32 v244, -1, v210, vcc
    s_waitcnt lgkmcnt(0)
    s_barrier
    s_branch L_count
L_code_end:
.section .rodata,"a"
.p2align 6
.amdhsa_kernel standalone__mpnn_edge_mlp__graph_kernel
  .amdhsa_next_free_vgpr 256
  .amdhsa_next_free_sgpr 102
  .amdhsa_accum_offset 256
  .amdhsa_group_segment_fixed_size 0
  .amdhsa_kernarg_size 72
  .amdhsa_user_sgpr_count 2
  .amdhsa_user_sgpr_kernarg_segment_ptr 1
  .amdhsa_system_sgpr_workgroup_id_x 1
.end_amdhsa_kernel
```
